```python
import torch

def _softmax(x, axis=-1):
    return torch.softmax(x, dim=axis)
def _gelu(x):
    return torch.nn.functional.gelu(x, approximate="tanh")
def _silu(x):
    return torch.nn.functional.silu(x)
def _sigmoid(x):
    return torch.sigmoid(x)
def _layernorm(x, axis=-1, eps=1e-5):
    m = x.mean(dim=axis, keepdim=True)
    v = x.var(dim=axis, keepdim=True, unbiased=False)
    return (x - m) / torch.sqrt(v + eps)
def _scatter_add(tgt, idx, src, axis=0):
    return tgt.clone().index_add_(axis, idx, src)
def _segment_sum(src, seg, n):
    out = torch.zeros((n,) + src.shape[1:], dtype=src.dtype)
    return out.index_add_(0, seg, src)
def _pad(x, pw):
    flat = tuple(v for pair in reversed(pw) for v in pair)
    return torch.nn.functional.pad(x, flat)

kernel_name = 'parallel_sum__ssm_conv_s4d__moe_arch_mod__prompt'

def setup_inputs():

    _w = (lambda a: (lambda t: t.to(torch.bfloat16) if t.is_floating_point() else t)(torch.as_tensor(a)))
    def _A_setup():
        Bsz, L, D, N = 1, 2048, 512, 128
        return {
            "u": _w((lambda *s: torch.randn(*s, dtype=torch.bfloat16) * 0.05)(Bsz, L, D)),
            "log_A_real": _w((lambda *s: torch.randn(*s, dtype=torch.bfloat16) * 3.2)(D, N) * 0.5),
            "A_imag": _w((lambda *s: torch.randn(*s, dtype=torch.bfloat16) * 0.1)(D, N) * 3.14),
            "C_real": _w((lambda *s: torch.randn(*s, dtype=torch.bfloat16) * 0.8)(D, N) / N ** 0.5),
            "C_imag": _w((lambda *s: torch.randn(*s, dtype=torch.bfloat16) * 0.8)(D, N) / N ** 0.5),
            "log_dt": _w((lambda *s: torch.randn(*s, dtype=torch.bfloat16) * 0.1)(D) * 0.5 - 4.0),
            "D_skip": _w((lambda *s: torch.randn(*s, dtype=torch.bfloat16) * 0.1)(D)),
        }
    _A_in = _A_setup()

    def _B_setup():
        B, S, D, F, C = 1, 2048, 512, 1792, 2
        return {
            "x": _w((lambda *s: torch.randn(*s, dtype=torch.bfloat16) * 0.05)(B, S, D)),
            "w_r": _w((lambda *s: torch.randn(*s, dtype=torch.bfloat16) * 0.05)(D)),
            "w_gate": _w((lambda *s: torch.randn(*s, dtype=torch.bfloat16) * 0.05)(D, F)),
            "w_up": _w((lambda *s: torch.randn(*s, dtype=torch.bfloat16) * 0.05)(D, F)),
            "w_down": _w((lambda *s: torch.randn(*s, dtype=torch.bfloat16) * 0.05)(F, D)),
        }
    _B_in = _B_setup()

    return {
        "A_u": _A_in["u"],
        "A_log_A_real": _A_in["log_A_real"],
        "A_A_imag": _A_in["A_imag"],
        "A_C_real": _A_in["C_real"],
        "A_C_imag": _A_in["C_imag"],
        "A_log_dt": _A_in["log_dt"],
        "A_D_skip": _A_in["D_skip"],
        "B_x": _B_in["x"],
        "B_w_r": _B_in["w_r"],
        "B_w_gate": _B_in["w_gate"],
        "B_w_up": _B_in["w_up"],
        "B_w_down": _B_in["w_down"],
    }

def reference(A_u, A_log_A_real, A_A_imag, A_C_real, A_C_imag, A_log_dt, A_D_skip, B_x, B_w_r, B_w_gate, B_w_up, B_w_down):
    def _A_ref(u, log_A_real, A_imag, C_real, C_imag, log_dt, D_skip):
        L = u.shape[1]
        dt = torch.exp(log_dt)
        A = -torch.exp(log_A_real) + 1j * A_imag
        C = (C_real + 1j * C_imag) * dt[:, None]
        pos = (lambda x, dt: x.to(dt))(torch.arange(L), log_dt.dtype)
        P = torch.exp((A * dt[:, None])[:, :, None] * pos[None, None, :])
        K = 2.0 * torch.einsum("dn,dnl->dl", C, P).real
        L2 = 2 * L
        u_t = (lambda x, *d: x.permute(*d))(u, 0, 2, 1)
        Kf = (lambda x, *a, **k: torch.fft.rfft(x.float(), *a, **k))(K, L2)
        Uf = (lambda x, *a, **k: torch.fft.rfft(x.float(), *a, **k))(u_t, L2)
        y = (lambda x, *a, **k: torch.fft.irfft(x, *a, **k).to(torch.bfloat16))(Uf * Kf[None, :, :], L2)[:, :, :L]
        y = (lambda x, *d: x.permute(*d))(y, 0, 2, 1)
        return y + u * D_skip[None, None, :]

    def _B_ref(x, w_r, w_gate, w_up, w_down):
        B, S, D = x.shape
        C = 2
        r = x @ w_r
        idx = torch.argsort(-r, axis=-1)[:, :C]
        idx_e = (lambda x, n, axis: torch.repeat_interleave(x, n, dim=axis))(idx.reshape(B, C, 1), D, axis=2)
        x_sel = (lambda x, i, axis: torch.take_along_dim(x, i, dim=axis))(x, idx_e, axis=1)
        g = _silu(x_sel @ w_gate)
        u = x_sel @ w_up
        y = (g * u) @ w_down
        r_sel = _sigmoid((lambda x, i, axis: torch.take_along_dim(x, i, dim=axis))(r, idx, axis=1))
        y = y * r_sel.reshape(B, C, 1)
        b_off = (torch.arange(B) * S).reshape(B, 1)
        flat_idx = (idx + b_off).reshape(B * C)
        zero = (x * 0.0).reshape(B * S, D)
        upd = _scatter_add(zero, flat_idx, y.reshape(B * C, D), axis=0)
        return x + upd.reshape(B, S, D)

    x = A_u
    xn = _layernorm(x, axis=-1)
    return x + _A_ref(xn, A_log_A_real, A_A_imag, A_C_real, A_C_imag, A_log_dt, A_D_skip) + _B_ref(xn, B_w_r, B_w_gate, B_w_up, B_w_down)
```

```asm
; @launch grid=(256,1,1) block=(512,1,1) lds=163840
.amdgcn_target "amdgcn-amd-amdhsa--gfx950"
.text
.globl parallel_sum__ssm_conv_s4d__moe_arch_mod__prompt_kernel
.p2align 8
.type parallel_sum__ssm_conv_s4d__moe_arch_mod__prompt_kernel,@function
parallel_sum__ssm_conv_s4d__moe_arch_mod__prompt_kernel:
  s_cmp_ge_u32 s2, 256
  s_cbranch_scc1 L_end
  s_getpc_b64 s[98:99]
L_pc:
  s_load_dwordx16 s[72:87], s[0:1], 0
  s_load_dwordx4 s[4:7], s[0:1], 96
  s_load_dwordx8 s[88:95], s[0:1], 64
  s_load_dwordx2 s[16:17], s[0:1], 112
  s_memrealtime s[70:71]
  s_movk_i32 s3, 384
  v_lshlrev_b32 v3, 6, v0
  v_min_u32 v3, L_tab_end-L_pc-4, v3
  s_cmp_lt_u32 s2, 16
  s_cselect_b64 vcc, -1, 0
  v_cmp_gt_u32 s[60:61], s3, v0
  s_and_b64 vcc, vcc, s[60:61]
  s_and_saveexec_b64 s[60:61], vcc
  s_cbranch_execz L_nopf
  global_load_dword v69, v3, s[98:99]
L_nopf:
  s_mov_b64 exec, -1
  v_lshrrev_b32 v3, 6, v0
  v_and_b32 v1, 63, v0
  s_and_b32 s57, s2, 7
  s_lshr_b32 s58, s2, 3
  v_readfirstlane_b32 s56, v3
  s_mov_b32 s10, 0x200000
  s_mov_b32 s11, 0x20000
  v_and_b32 v3, 7, v1
  v_lshrrev_b32 v4, 3, v1
  v_lshlrev_b32 v78, 11, v3
  v_lshl_or_b32 v78, v4, 2, v78
  v_lshlrev_b32 v7, 4, v1
  v_lshlrev_b32 v79, 1, v1
  v_mov_b32 v8, 0
  s_lshr_b32 s63, s56, 1
  s_lshl_b32 s63, s63, 4
  s_lshl_b32 s64, s58, 6
  s_add_u32 s63, s63, s64
  s_lshl_b32 s63, s63, 10
  s_lshl_b32 s64, s57, 7
  s_add_u32 s63, s63, s64
  s_and_b32 s65, s56, 1
  s_lshl_b32 s64, s65, 6
  s_add_u32 s63, s63, s64
  s_lshl_b32 s64, s2, 3
  s_lshl_b32 s68, s56, 1
  s_add_u32 s64, s64, s68
  s_lshl_b32 s64, s64, 10
  s_bfe_u32 s66, s56, 0x10001
  s_lshl_b32 s59, s57, 5
  s_add_u32 s59, s59, s58
  s_lshl_b32 s67, s59, 1
  s_add_u32 s67, s67, s66
  s_lshl_b32 s61, s67, 1
  s_lshl_b32 s67, s67, 8
  s_lshl_b32 s68, s65, 7
  s_add_u32 s67, s67, s68
  s_waitcnt lgkmcnt(0)
  s_mov_b64 s[8:9], s[72:73]
  s_mov_b64 s[52:53], s[6:7]
  s_mov_b32 s54, 256
  s_mov_b32 s55, s11
  s_or_b32 s68, s2, s56
  s_cmp_lg_u32 s68, 0
  s_cbranch_scc1 L_nononce
  s_or_b32 s68, s70, 1
  v_mov_b32 v3, s68
  s_mov_b64 exec, 1
  buffer_store_dword v3, v8, s[52:55], 0 offen sc1
  s_mov_b64 exec, -1
L_nononce:
  s_cmp_ge_u32 s56, 4
  s_cbranch_scc1 L_tileL
  buffer_load_dword v80, v78, s[8:11], s63 offen offset:0
  buffer_load_dword v81, v78, s[8:11], s63 offen offset:1024
  buffer_load_dword v84, v78, s[8:11], s63 offen offset:32
  buffer_load_dword v85, v78, s[8:11], s63 offen offset:1056
  buffer_load_dwordx4 v[88:91], v7, s[8:11], s64 offen
  buffer_load_dwordx4 v[92:95], v7, s[8:11], s64 offen offset:1024
  s_branch L_args
L_tileL:
  s_mov_b64 s[20:21], s[74:75]
  s_mov_b64 s[24:25], s[76:77]
  s_mov_b64 s[28:29], s[78:79]
  s_mov_b64 s[32:33], s[80:81]
  s_mov_b32 s22, 0x20000
  s_mov_b32 s23, s11
  s_mov_b32 s26, 0x20000
  s_mov_b32 s27, s11
  s_mov_b32 s30, 0x20000
  s_mov_b32 s31, s11
  s_mov_b32 s34, 0x20000
  s_mov_b32 s35, s11
  buffer_load_ushort v100, v79, s[20:23], s67 offen
  buffer_load_ushort v101, v79, s[24:27], s67 offen
  buffer_load_ushort v102, v79, s[28:31], s67 offen
  buffer_load_ushort v103, v79, s[32:35], s67 offen
  s_add_u32 s82, s82, s61
  s_addc_u32 s83, s83, 0
  global_load_ushort v104, v8, s[82:83]
  buffer_load_dword v80, v78, s[8:11], s63 offen offset:0
  buffer_load_dword v81, v78, s[8:11], s63 offen offset:1024
  buffer_load_dword v84, v78, s[8:11], s63 offen offset:32
  buffer_load_dword v85, v78, s[8:11], s63 offen offset:1056
L_args:
  s_mov_b64 s[12:13], s[4:5]
  s_mov_b64 s[4:5], s[84:85]
  s_mov_b32 s18, 0x10000000
  s_mov_b32 s19, s11
  s_mov_b32 s14, 0x200000
  s_mov_b32 s15, s11
  v_mov_b32 v9, 0
  v_mov_b32 v10, 1
  v_lshlrev_b32 v11, 4, v0
  s_mov_b64 s[40:41], s[90:91]
  s_mov_b64 s[44:45], s[92:93]
  s_mov_b64 s[48:49], s[94:95]
  s_mov_b32 s42, 1835008
  s_mov_b32 s43, s11
  s_mov_b32 s46, 1835008
  s_mov_b32 s47, s11
  s_mov_b32 s50, 1835008
  s_mov_b32 s51, s11
  s_mul_i32 s100, s57, 14
  s_add_u32 s100, s100, s58
  s_sub_u32 s101, s56, 4
  s_cmp_lt_u32 s56, 4
  s_cbranch_scc1 L_early_E
  s_lshl_b32 s68, s58, 2
  s_add_u32 s68, s68, s101
  s_lshl_b32 s69, s68, 2
  v_bfe_u32 v4, v1, 3, 2
  v_add_u32 v4, s69, v4
  v_mul_u32_u24 v4, 3584, v4
  v_and_b32 v5, 7, v1
  v_lshl_add_u32 v4, v5, 6, v4
  s_mul_i32 s69, s57, 448
  s_and_b32 s69, s69, 0xffffff80
  s_mov_b32 exec_lo, 0xffffffff
  s_mov_b32 exec_hi, 0
  buffer_load_dword v69, v4, s[40:43], s69 offen
  s_mov_b64 exec, -1
  s_add_u32 s92, s98, L_tab_idx-L_pc+4128
  s_addc_u32 s93, s99, 0
  v_and_b32 v3, 0xfff, v11
  global_load_dwordx4 v[106:109], v3, s[92:93]
  global_load_dwordx4 v[110:113], v3, s[92:93] offset:16
  s_branch L_init
L_early_E:
  s_mov_b64 s[36:37], s[88:89]
  s_mov_b32 s38, 1024
  s_mov_b32 s39, s11
  buffer_load_dwordx4 v[96:99], v7, s[36:39], 0 offen
  s_cmp_lg_u32 s56, 0
  s_cbranch_scc1 L_nop0
  buffer_load_dword v114, v8, s[52:55], 0 offen sc1
L_nop0:
  s_add_u32 s92, s98, L_tab_idx-L_pc+0
  s_addc_u32 s93, s99, 0
  v_and_b32 v3, 0xfff, v11
  global_load_dwordx4 v[106:109], v3, s[92:93]
  global_load_dwordx4 v[110:113], v3, s[92:93] offset:16
  v_lshrrev_b32 v3, 7, v0
  v_mul_u32_u24 v3, 6144, v3
  v_and_b32 v4, 127, v0
  v_lshl_add_u32 v3, v4, 2, v3
  ds_write_b32 v3, v8 offset:1536
  v_lshlrev_b32 v3, 2, v1
  ds_write_b32 v3, v8 offset:12288
L_init:
  s_waitcnt lgkmcnt(0)
  s_barrier
  v_and_b32 v3, 7, v1
  v_lshrrev_b32 v4, 3, v1
  v_lshlrev_b32 v4, 9, v4
  v_lshl_or_b32 v117, v3, 4, v4
  s_lshl_b32 s72, s59, 14
  s_lshl_b32 s68, s65, 13
  s_add_u32 s72, s72, s68
  s_lshr_b32 s68, s56, 1
  s_lshl_b32 s68, s68, 7
  s_add_u32 s72, s72, s68
  s_add_u32 s73, s72, 4096
  v_lshrrev_b32 v3, 5, v0
  v_lshlrev_b32 v3, 14, v3
  v_and_b32 v4, 31, v0
  v_lshl_or_b32 v13, v4, 4, v3
  s_lshl_b32 s74, s57, 19
  s_lshl_b32 s68, s58, 9
  s_add_u32 s74, s74, s68
  s_add_u32 s75, s74, 0x40000
  s_mov_b32 s76, 4194304
  s_mov_b32 s77, 4202496
  s_mul_i32 s68, s66, 34816
  s_lshl_b32 s69, s65, 8
  s_add_u32 s68, s68, s69
  s_add_u32 s68, s68, 25600
  v_lshl_add_u32 v118, v1, 2, s68
  v_and_b32 v15, 15, v1
  v_lshrrev_b32 v16, 4, v1
  v_mul_u32_u24 v3, 544, v15
  v_lshl_add_u32 v3, v16, 4, v3
  s_lshr_b32 s69, s56, 1
  s_mul_i32 s68, s65, 34816
  s_add_u32 s68, s68, 25600
  s_add_u32 s78, s69, 1
  s_mul_i32 s78, s78, 8704
  s_add_u32 s78, s78, s68
  s_cmp_eq_u32 s69, 2
  s_cselect_b32 s79, s68, s78
  s_cselect_b32 s80, s78, s68
  v_add_u32 v119, s79, v3
  v_add_u32 v120, s80, v3
  s_mul_i32 s68, s65, 6144
  s_lshl_b32 s69, s69, 9
  s_add_u32 s68, s68, s69
  v_lshl_add_u32 v121, v1, 3, s68
  v_lshlrev_b32 v14, 2, v0
  v_add_u32 v14, 2048, v14
  v_bfe_u32 v3, v0, 3, 4
  v_bfe_u32 v4, v0, 1, 2
  v_lshrrev_b32 v5, 1, v3
  v_add_u32 v4, v4, v5
  v_and_b32 v4, 3, v4
  v_lshlrev_b32 v4, 4, v4
  v_lshl_add_u32 v4, v3, 6, v4
  v_lshrrev_b32 v5, 7, v0
  v_and_b32 v5, 3, v5
  v_lshl_add_u32 v4, v5, 10, v4
  v_and_b32 v5, 1, v0
  v_lshl_add_u32 v4, v5, 3, v4
  v_add_u32 v20, 95232, v4
  v_and_b32 v12, 255, v0
  v_lshlrev_b32 v12, 2, v12
  s_lshl_b32 s68, s59, 2
  s_add_u32 s4, s4, s68
  s_addc_u32 s5, s5, 0
  global_load_dword v68, v8, s[4:5]
  s_cmp_ge_u32 s56, 4
  s_cbranch_scc1 L_roleL
  s_cmp_lg_u32 s56, 0
  s_cbranch_scc1 L_nop1
  buffer_load_dword v115, v8, s[52:55], 0 offen sc1
L_nop1:
  s_cmp_lg_u32 s56, 0
  s_cbranch_scc1 L_npoll_done
  s_mov_b32 s68, 0
  buffer_load_dword v116, v8, s[52:55], 0 offen sc1
  s_waitcnt vmcnt(5)
  v_readfirstlane_b32 s60, v114
  s_cmp_lg_u32 s60, 0
  s_cbranch_scc1 L_npoll_ok
  s_mov_b32 s68, 1
  s_waitcnt vmcnt(1)
  v_readfirstlane_b32 s60, v115
  s_cmp_lg_u32 s60, 0
  s_cbranch_scc1 L_npoll_ok
  s_mov_b32 s68, 2
  s_waitcnt vmcnt(0)
  v_readfirstlane_b32 s60, v116
  s_cmp_lg_u32 s60, 0
  s_cbranch_scc1 L_npoll_ok
L_npoll:
  buffer_load_dword v3, v8, s[52:55], 0 offen sc1
  s_waitcnt vmcnt(0)
  v_readfirstlane_b32 s60, v3
  s_add_u32 s68, s68, 1
  s_cmp_lg_u32 s60, 0
  s_cbranch_scc1 L_npoll_ok
  s_cmp_lt_u32 s68, 200000
  s_cbranch_scc1 L_npoll
L_npoll_ok:
  v_mov_b32 v122, s60
  ds_write_b32 v8, v122 offset:12288
  s_branch L_tagE
L_npoll_done:
  s_mov_b32 s69, 0
L_spin1:
  ds_read_b32 v6, v8 offset:12288
  s_add_u32 s69, s69, 1
  s_waitcnt lgkmcnt(0)
  v_readfirstlane_b32 s68, v6
  s_cmp_ge_u32 s68, 1
  s_cbranch_scc1 L_spin1_go
  s_cmp_lt_u32 s69, 4000000
  s_cbranch_scc1 L_spin1
L_spin1_go:
  s_mov_b32 s60, s68
  v_mov_b32 v122, s68
L_tagE:
  v_mov_b32 v82, v122
  v_mov_b32 v83, v122
  v_mov_b32 v86, v122
  v_mov_b32 v87, v122
  s_waitcnt vmcnt(6)
  buffer_store_dwordx4 v[80:83], v117, s[16:19], s72 offen sc1
  buffer_store_dwordx4 v[84:87], v117, s[16:19], s73 offen sc1
  v_mov_b32 v172, 0x3f803f80
  v_mov_b32 v160, 0
  v_mov_b32 v162, 0
  v_mov_b32 v161, 0
  v_mov_b32 v163, 0
  s_waitcnt vmcnt(6)
  v_dot2_f32_bf16 v160, v88, v172, v160
  v_dot2_f32_bf16 v162, v88, v88, v162
  v_dot2_f32_bf16 v161, v92, v172, v161
  v_dot2_f32_bf16 v163, v92, v92, v163
  v_dot2_f32_bf16 v160, v89, v172, v160
  v_dot2_f32_bf16 v162, v89, v89, v162
  v_dot2_f32_bf16 v161, v93, v172, v161
  v_dot2_f32_bf16 v163, v93, v93, v163
  v_dot2_f32_bf16 v160, v90, v172, v160
  v_dot2_f32_bf16 v162, v90, v90, v162
  v_dot2_f32_bf16 v161, v94, v172, v161
  v_dot2_f32_bf16 v163, v94, v94, v163
  v_dot2_f32_bf16 v160, v91, v172, v160
  v_dot2_f32_bf16 v162, v91, v91, v162
  v_dot2_f32_bf16 v161, v95, v172, v161
  v_dot2_f32_bf16 v163, v95, v95, v163
  v_lshlrev_b32 v144, 16, v88
  v_and_b32 v145, 0xffff0000, v88
  v_lshlrev_b32 v152, 16, v92
  v_and_b32 v153, 0xffff0000, v92
  v_lshlrev_b32 v146, 16, v89
  v_and_b32 v147, 0xffff0000, v89
  v_lshlrev_b32 v154, 16, v93
  v_and_b32 v155, 0xffff0000, v93
  v_add_f32_dpp v160, v160, v160 row_shr:1 row_mask:0xf bank_mask:0xf bound_ctrl:0
  v_add_f32_dpp v161, v161, v161 row_shr:1 row_mask:0xf bank_mask:0xf bound_ctrl:0
  v_add_f32_dpp v162, v162, v162 row_shr:1 row_mask:0xf bank_mask:0xf bound_ctrl:0
  v_add_f32_dpp v163, v163, v163 row_shr:1 row_mask:0xf bank_mask:0xf bound_ctrl:0
  v_add_f32_dpp v160, v160, v160 row_shr:2 row_mask:0xf bank_mask:0xf bound_ctrl:0
  v_add_f32_dpp v161, v161, v161 row_shr:2 row_mask:0xf bank_mask:0xf bound_ctrl:0
  v_add_f32_dpp v162, v162, v162 row_shr:2 row_mask:0xf bank_mask:0xf bound_ctrl:0
  v_add_f32_dpp v163, v163, v163 row_shr:2 row_mask:0xf bank_mask:0xf bound_ctrl:0
  v_add_f32_dpp v160, v160, v160 row_shr:4 row_mask:0xf bank_mask:0xf bound_ctrl:0
  v_add_f32_dpp v161, v161, v161 row_shr:4 row_mask:0xf bank_mask:0xf bound_ctrl:0
  v_add_f32_dpp v162, v162, v162 row_shr:4 row_mask:0xf bank_mask:0xf bound_ctrl:0
  v_add_f32_dpp v163, v163, v163 row_shr:4 row_mask:0xf bank_mask:0xf bound_ctrl:0
  v_add_f32_dpp v160, v160, v160 row_shr:8 row_mask:0xf bank_mask:0xf bound_ctrl:0
  v_add_f32_dpp v161, v161, v161 row_shr:8 row_mask:0xf bank_mask:0xf bound_ctrl:0
  v_add_f32_dpp v162, v162, v162 row_shr:8 row_mask:0xf bank_mask:0xf bound_ctrl:0
  v_add_f32_dpp v163, v163, v163 row_shr:8 row_mask:0xf bank_mask:0xf bound_ctrl:0
  v_add_f32_dpp v160, v160, v160 row_bcast:15 row_mask:0xa bank_mask:0xf
  v_add_f32_dpp v161, v161, v161 row_bcast:15 row_mask:0xa bank_mask:0xf
  v_add_f32_dpp v162, v162, v162 row_bcast:15 row_mask:0xa bank_mask:0xf
  v_add_f32_dpp v163, v163, v163 row_bcast:15 row_mask:0xa bank_mask:0xf
  v_add_f32_dpp v160, v160, v160 row_bcast:31 row_mask:0xc bank_mask:0xf
  v_add_f32_dpp v161, v161, v161 row_bcast:31 row_mask:0xc bank_mask:0xf
  v_add_f32_dpp v162, v162, v162 row_bcast:31 row_mask:0xc bank_mask:0xf
  v_add_f32_dpp v163, v163, v163 row_bcast:31 row_mask:0xc bank_mask:0xf
  v_lshlrev_b32 v148, 16, v90
  v_and_b32 v149, 0xffff0000, v90
  v_lshlrev_b32 v156, 16, v94
  v_and_b32 v157, 0xffff0000, v94
  v_lshlrev_b32 v150, 16, v91
  v_and_b32 v151, 0xffff0000, v91
  v_lshlrev_b32 v158, 16, v95
  v_and_b32 v159, 0xffff0000, v95
  v_mul_f32 v160, 0x3b000000, v160
  v_mul_f32 v162, 0x3b000000, v162
  v_mul_f32 v161, 0x3b000000, v161
  v_mul_f32 v163, 0x3b000000, v163
  v_fma_f32 v162, -v160, v160, v162
  v_fma_f32 v163, -v161, v161, v163
  v_max_f32 v162, 0, v162
  v_max_f32 v163, 0, v163
  v_cvt_pk_bf16_f32 v182, v160, v162
  v_cvt_pk_bf16_f32 v183, v161, v163
  v_and_b32 v184, 0xffff0000, v182
  v_and_b32 v185, 0xffff0000, v183
  v_add_f32 v184, 0x3727c5ac, v184
  v_add_f32 v185, 0x3727c5ac, v185
  v_cvt_pk_bf16_f32 v184, v184, v184
  v_cvt_pk_bf16_f32 v185, v185, v185
  v_and_b32 v184, 0xffff0000, v184
  v_and_b32 v185, 0xffff0000, v185
  v_sqrt_f32 v184, v184
  v_sqrt_f32 v185, v185
  v_and_b32 v178, 0xffff, v182
  v_and_b32 v179, 0xffff, v183
  v_cvt_pk_bf16_f32 v184, v184, v184
  v_cvt_pk_bf16_f32 v185, v185, v185
  v_and_b32 v184, 0xffff0000, v184
  v_and_b32 v185, 0xffff0000, v185
  v_rcp_f32 v173, v184
  v_rcp_f32 v174, v185
  v_lshlrev_b32 v182, 16, v182
  v_or_b32 v178, v178, v184
  v_lshlrev_b32 v183, 16, v183
  v_or_b32 v179, v179, v185
  v_mul_f32 v175, v182, v173
  v_mul_f32 v176, v183, v174
  v_readlane_b32 s84, v173, 63
  v_readlane_b32 s86, v175, 63
  v_readlane_b32 s85, v174, 63
  v_readlane_b32 s87, v176, 63
  v_mov_b32 v173, s84
  v_mov_b32 v175, s86
  v_mov_b32 v174, s85
  v_mov_b32 v176, s87
  v_fma_f32 v144, v144, v173, -v175
  v_fma_f32 v152, v152, v174, -v176
  v_fma_f32 v145, v145, v173, -v175
  v_fma_f32 v153, v153, v174, -v176
  v_fma_f32 v146, v146, v173, -v175
  v_fma_f32 v154, v154, v174, -v176
  v_fma_f32 v147, v147, v173, -v175
  v_fma_f32 v155, v155, v174, -v176
  v_fma_f32 v148, v148, v173, -v175
  v_fma_f32 v156, v156, v174, -v176
  v_fma_f32 v149, v149, v173, -v175
  v_fma_f32 v157, v157, v174, -v176
  v_fma_f32 v150, v150, v173, -v175
  v_fma_f32 v158, v158, v174, -v176
  v_fma_f32 v151, v151, v173, -v175
  v_fma_f32 v159, v159, v174, -v176
  v_cvt_pk_bf16_f32 v164, v144, v145
  v_cvt_pk_bf16_f32 v168, v152, v153
  v_cvt_pk_bf16_f32 v165, v146, v147
  v_cvt_pk_bf16_f32 v169, v154, v155
  v_cvt_pk_bf16_f32 v166, v148, v149
  v_cvt_pk_bf16_f32 v170, v156, v157
  v_cvt_pk_bf16_f32 v167, v150, v151
  v_cvt_pk_bf16_f32 v171, v158, v159
  v_mov_b32 v160, 0
  v_mov_b32 v161, 0
  s_waitcnt vmcnt(5)
  v_dot2_f32_bf16 v160, v164, v96, v160
  v_dot2_f32_bf16 v161, v168, v96, v161
  v_dot2_f32_bf16 v160, v165, v97, v160
  v_dot2_f32_bf16 v161, v169, v97, v161
  v_dot2_f32_bf16 v160, v166, v98, v160
  v_dot2_f32_bf16 v161, v170, v98, v161
  v_dot2_f32_bf16 v160, v167, v99, v160
  v_dot2_f32_bf16 v161, v171, v99, v161
  v_mov_b32 v181, v122
  s_lshl_b32 s68, s2, 2
  s_add_u32 s68, s68, s56
  s_lshl_b32 s68, s68, 4
  s_add_u32 s68, s68, 4194304
  v_add_f32_dpp v160, v160, v160 row_shr:1 row_mask:0xf bank_mask:0xf bound_ctrl:0
  v_add_f32_dpp v161, v161, v161 row_shr:1 row_mask:0xf bank_mask:0xf bound_ctrl:0
  s_nop 0
  v_add_f32_dpp v160, v160, v160 row_shr:2 row_mask:0xf bank_mask:0xf bound_ctrl:0
  v_add_f32_dpp v161, v161, v161 row_shr:2 row_mask:0xf bank_mask:0xf bound_ctrl:0
  s_nop 0
  v_add_f32_dpp v160, v160, v160 row_shr:4 row_mask:0xf bank_mask:0xf bound_ctrl:0
  v_add_f32_dpp v161, v161, v161 row_shr:4 row_mask:0xf bank_mask:0xf bound_ctrl:0
  s_nop 0
  v_add_f32_dpp v160, v160, v160 row_shr:8 row_mask:0xf bank_mask:0xf bound_ctrl:0
  v_add_f32_dpp v161, v161, v161 row_shr:8 row_mask:0xf bank_mask:0xf bound_ctrl:0
  s_nop 0
  v_add_f32_dpp v160, v160, v160 row_bcast:15 row_mask:0xa bank_mask:0xf
  v_add_f32_dpp v161, v161, v161 row_bcast:15 row_mask:0xa bank_mask:0xf
  s_nop 0
  v_add_f32_dpp v160, v160, v160 row_bcast:31 row_mask:0xc bank_mask:0xf
  v_add_f32_dpp v161, v161, v161 row_bcast:31 row_mask:0xc bank_mask:0xf
  v_cvt_pk_bf16_f32 v180, v160, v161
  s_mov_b32 exec_lo, 0
  s_mov_b32 exec_hi, 0x80000000
  buffer_store_dwordx4 v[178:181], v8, s[16:19], s68 offen sc1
  s_mov_b64 exec, -1
  s_mov_b32 s69, 0
L_spin2:
  ds_read_b32 v6, v8 offset:12296
  s_add_u32 s69, s69, 1
  s_waitcnt lgkmcnt(0)
  v_readfirstlane_b32 s68, v6
  s_cmp_ge_u32 s68, 4
  s_cbranch_scc1 L_spin2_go
  s_cmp_lt_u32 s69, 4000000
  s_cbranch_scc1 L_spin2
L_spin2_go:
  ds_read_b128 v[126:129], v11 offset:21504
  s_waitcnt lgkmcnt(0)
  v_mul_f32 v131, 0x40000000, v126
  v_mul_f32 v132, 0x40000000, v127
  v_mul_f32 v133, 0x43000000, v126
  v_mul_f32 v130, 0x43000000, v127
  v_exp_f32 v131, v131
  v_fract_f32 v132, v132
  v_exp_f32 v133, v133
  v_fract_f32 v130, v130
  v_cos_f32 v144, v132
  v_sin_f32 v145, v132
  v_cos_f32 v146, v130
  v_sin_f32 v147, v130
  v_mul_f32 v144, v144, v131
  v_mul_f32 v145, v145, v131
  v_mul_f32 v146, v146, v133
  v_mul_f32 v147, v147, v133
  v_pk_mul_f32 v[148:149], v[144:145], v[144:145] op_sel:[0,0] op_sel_hi:[0,1]
  v_pk_fma_f32 v[148:149], v[144:145], v[144:145], v[148:149] op_sel:[1,1,0] op_sel_hi:[1,0,1] neg_lo:[1,0,0]
  v_pk_mul_f32 v[150:151], v[146:147], v[146:147] op_sel:[0,0] op_sel_hi:[0,1]
  v_pk_fma_f32 v[150:151], v[146:147], v[146:147], v[150:151] op_sel:[1,1,0] op_sel_hi:[1,0,1] neg_lo:[1,0,0]
  v_pk_mul_f32 v[152:153], v[144:145], v[148:149] op_sel:[0,0] op_sel_hi:[0,1]
  v_pk_fma_f32 v[152:153], v[144:145], v[148:149], v[152:153] op_sel:[1,1,0] op_sel_hi:[1,0,1] neg_lo:[1,0,0]
  v_pk_mul_f32 v[154:155], v[150:151], v[150:151] op_sel:[0,0] op_sel_hi:[0,1]
  v_pk_fma_f32 v[154:155], v[150:151], v[150:151], v[154:155] op_sel:[1,1,0] op_sel_hi:[1,0,1] neg_lo:[1,0,0]
  v_pk_mul_f32 v[156:157], v[148:149], v[146:147] op_sel:[0,0] op_sel_hi:[0,1]
  v_pk_fma_f32 v[156:157], v[148:149], v[146:147], v[156:157] op_sel:[1,1,0] op_sel_hi:[1,0,1] neg_lo:[1,0,0]
  v_pk_mul_f32 v[158:159], v[128:129], v[150:151] op_sel:[0,0] op_sel_hi:[0,1]
  v_pk_fma_f32 v[158:159], v[128:129], v[150:151], v[158:159] op_sel:[1,1,0] op_sel_hi:[1,0,1] neg_lo:[1,0,0]
  v_pk_mul_f32 v[160:161], v[128:129], v[154:155] op_sel:[0,0] op_sel_hi:[0,1]
  v_pk_fma_f32 v[160:161], v[128:129], v[154:155], v[160:161] op_sel:[1,1,0] op_sel_hi:[1,0,1] neg_lo:[1,0,0]
  v_pk_mul_f32 v[162:163], v[158:159], v[146:147] op_sel:[0,0] op_sel_hi:[0,1]
  v_pk_fma_f32 v[162:163], v[158:159], v[146:147], v[162:163] op_sel:[1,1,0] op_sel_hi:[1,0,1] neg_lo:[1,0,0]
  v_pk_mul_f32 v[164:165], v[160:161], v[150:151] op_sel:[0,0] op_sel_hi:[0,1]
  v_pk_fma_f32 v[164:165], v[160:161], v[150:151], v[164:165] op_sel:[1,1,0] op_sel_hi:[1,0,1] neg_lo:[1,0,0]
  v_pk_mul_f32 v[166:167], v[154:155], v[154:155] op_sel:[0,0] op_sel_hi:[0,1]
  v_pk_fma_f32 v[166:167], v[154:155], v[154:155], v[166:167] op_sel:[1,1,0] op_sel_hi:[1,0,1] neg_lo:[1,0,0]
  v_pk_mul_f32 v[168:169], v[146:147], v[150:151] op_sel:[0,0] op_sel_hi:[0,1]
  v_pk_fma_f32 v[168:169], v[146:147], v[150:151], v[168:169] op_sel:[1,1,0] op_sel_hi:[1,0,1] neg_lo:[1,0,0]
  v_pk_mul_f32 v[138:139], v[158:159], v[144:145] op_sel:[0,0] op_sel_hi:[0,1]
  v_pk_mul_f32 v[140:141], v[158:159], v[148:149] op_sel:[0,0] op_sel_hi:[0,1]
  v_pk_mul_f32 v[142:143], v[158:159], v[152:153] op_sel:[0,0] op_sel_hi:[0,1]
  v_cvt_pk_bf16_f32 v131, v158, v159
  ds_write_b32 v118, v131 offset:17408
  v_pk_fma_f32 v[138:139], v[158:159], v[144:145], v[138:139] op_sel:[1,1,0] op_sel_hi:[1,0,1] neg_lo:[1,0,0]
  v_pk_fma_f32 v[140:141], v[158:159], v[148:149], v[140:141] op_sel:[1,1,0] op_sel_hi:[1,0,1] neg_lo:[1,0,0]
  v_pk_fma_f32 v[142:143], v[158:159], v[152:153], v[142:143] op_sel:[1,1,0] op_sel_hi:[1,0,1] neg_lo:[1,0,0]
  v_cvt_pk_bf16_f32 v132, v138, v139
  ds_write_b32 v118, v132 offset:17952
  v_cvt_pk_bf16_f32 v133, v140, v141
  ds_write_b32 v118, v133 offset:18496
  v_cvt_pk_bf16_f32 v130, v142, v143
  ds_write_b32 v118, v130 offset:19040
  v_pk_mul_f32 v[158:159], v[128:129], v[166:167] op_sel:[0,0] op_sel_hi:[0,1]
  v_pk_fma_f32 v[158:159], v[128:129], v[166:167], v[158:159] op_sel:[1,1,0] op_sel_hi:[1,0,1] neg_lo:[1,0,0]
  v_pk_mul_f32 v[170:171], v[166:167], v[166:167] op_sel:[0,0] op_sel_hi:[0,1]
  v_pk_fma_f32 v[170:171], v[166:167], v[166:167], v[170:171] op_sel:[1,1,0] op_sel_hi:[1,0,1] neg_lo:[1,0,0]
  v_pk_mul_f32 v[138:139], v[162:163], v[144:145] op_sel:[0,0] op_sel_hi:[0,1]
  v_pk_mul_f32 v[140:141], v[162:163], v[148:149] op_sel:[0,0] op_sel_hi:[0,1]
  v_pk_mul_f32 v[142:143], v[162:163], v[152:153] op_sel:[0,0] op_sel_hi:[0,1]
  v_cvt_pk_bf16_f32 v131, v162, v163
  ds_write_b32 v118, v131 offset:19584
  v_pk_fma_f32 v[138:139], v[162:163], v[144:145], v[138:139] op_sel:[1,1,0] op_sel_hi:[1,0,1] neg_lo:[1,0,0]
  v_pk_fma_f32 v[140:141], v[162:163], v[148:149], v[140:141] op_sel:[1,1,0] op_sel_hi:[1,0,1] neg_lo:[1,0,0]
  v_pk_fma_f32 v[142:143], v[162:163], v[152:153], v[142:143] op_sel:[1,1,0] op_sel_hi:[1,0,1] neg_lo:[1,0,0]
  v_cvt_pk_bf16_f32 v132, v138, v139
  ds_write_b32 v118, v132 offset:20128
  v_cvt_pk_bf16_f32 v133, v140, v141
  ds_write_b32 v118, v133 offset:20672
  v_cvt_pk_bf16_f32 v130, v142, v143
  ds_write_b32 v118, v130 offset:21216
  v_pk_mul_f32 v[162:163], v[158:159], v[154:155] op_sel:[0,0] op_sel_hi:[0,1]
  v_pk_fma_f32 v[162:163], v[158:159], v[154:155], v[162:163] op_sel:[1,1,0] op_sel_hi:[1,0,1] neg_lo:[1,0,0]
  v_pk_mul_f32 v[138:139], v[160:161], v[148:149] op_sel:[0,0] op_sel_hi:[0,1]
  v_pk_mul_f32 v[140:141], v[160:161], v[146:147] op_sel:[0,0] op_sel_hi:[0,1]
  v_pk_mul_f32 v[142:143], v[160:161], v[156:157] op_sel:[0,0] op_sel_hi:[0,1]
  v_cvt_pk_bf16_f32 v131, v160, v161
  ds_write_b32 v118, v131 offset:21760
  v_pk_fma_f32 v[138:139], v[160:161], v[148:149], v[138:139] op_sel:[1,1,0] op_sel_hi:[1,0,1] neg_lo:[1,0,0]
  v_pk_fma_f32 v[140:141], v[160:161], v[146:147], v[140:141] op_sel:[1,1,0] op_sel_hi:[1,0,1] neg_lo:[1,0,0]
  v_pk_fma_f32 v[142:143], v[160:161], v[156:157], v[142:143] op_sel:[1,1,0] op_sel_hi:[1,0,1] neg_lo:[1,0,0]
  v_cvt_pk_bf16_f32 v132, v138, v139
  ds_write_b32 v118, v132 offset:22304
  v_cvt_pk_bf16_f32 v133, v140, v141
  ds_write_b32 v118, v133 offset:22848
  v_cvt_pk_bf16_f32 v130, v142, v143
  ds_write_b32 v118, v130 offset:23392
  v_pk_mul_f32 v[160:161], v[128:129], v[170:171] op_sel:[0,0] op_sel_hi:[0,1]
  v_pk_fma_f32 v[160:161], v[128:129], v[170:171], v[160:161] op_sel:[1,1,0] op_sel_hi:[1,0,1] neg_lo:[1,0,0]
  v_pk_mul_f32 v[138:139], v[164:165], v[148:149] op_sel:[0,0] op_sel_hi:[0,1]
  v_pk_mul_f32 v[140:141], v[164:165], v[146:147] op_sel:[0,0] op_sel_hi:[0,1]
  v_pk_mul_f32 v[142:143], v[164:165], v[156:157] op_sel:[0,0] op_sel_hi:[0,1]
  v_cvt_pk_bf16_f32 v131, v164, v165
  ds_write_b32 v118, v131 offset:23936
  v_pk_fma_f32 v[138:139], v[164:165], v[148:149], v[138:139] op_sel:[1,1,0] op_sel_hi:[1,0,1] neg_lo:[1,0,0]
  v_pk_fma_f32 v[140:141], v[164:165], v[146:147], v[140:141] op_sel:[1,1,0] op_sel_hi:[1,0,1] neg_lo:[1,0,0]
  v_pk_fma_f32 v[142:143], v[164:165], v[156:157], v[142:143] op_sel:[1,1,0] op_sel_hi:[1,0,1] neg_lo:[1,0,0]
  v_cvt_pk_bf16_f32 v132, v138, v139
  ds_write_b32 v118, v132 offset:24480
  v_cvt_pk_bf16_f32 v133, v140, v141
  ds_write_b32 v118, v133 offset:25024
  v_cvt_pk_bf16_f32 v130, v142, v143
  ds_write_b32 v118, v130 offset:25568
  v_pk_mul_f32 v[138:139], v[158:159], v[146:147] op_sel:[0,0] op_sel_hi:[0,1]
  v_pk_mul_f32 v[140:141], v[158:159], v[150:151] op_sel:[0,0] op_sel_hi:[0,1]
  v_pk_mul_f32 v[142:143], v[158:159], v[168:169] op_sel:[0,0] op_sel_hi:[0,1]
  v_cvt_pk_bf16_f32 v131, v158, v159
  ds_write_b32 v118, v131 offset:26112
  v_pk_fma_f32 v[138:139], v[158:159], v[146:147], v[138:139] op_sel:[1,1,0] op_sel_hi:[1,0,1] neg_lo:[1,0,0]
  v_pk_fma_f32 v[140:141], v[158:159], v[150:151], v[140:141] op_sel:[1,1,0] op_sel_hi:[1,0,1] neg_lo:[1,0,0]
  v_pk_fma_f32 v[142:143], v[158:159], v[168:169], v[142:143] op_sel:[1,1,0] op_sel_hi:[1,0,1] neg_lo:[1,0,0]
  v_cvt_pk_bf16_f32 v132, v138, v139
  ds_write_b32 v118, v132 offset:26656
  v_cvt_pk_bf16_f32 v133, v140, v141
  ds_write_b32 v118, v133 offset:27200
  v_cvt_pk_bf16_f32 v130, v142, v143
  ds_write_b32 v118, v130 offset:27744
  v_pk_mul_f32 v[138:139], v[162:163], v[146:147] op_sel:[0,0] op_sel_hi:[0,1]
  v_pk_mul_f32 v[140:141], v[162:163], v[150:151] op_sel:[0,0] op_sel_hi:[0,1]
  v_pk_mul_f32 v[142:143], v[162:163], v[168:169] op_sel:[0,0] op_sel_hi:[0,1]
  v_cvt_pk_bf16_f32 v131, v162, v163
  ds_write_b32 v118, v131 offset:28288
  v_pk_fma_f32 v[138:139], v[162:163], v[146:147], v[138:139] op_sel:[1,1,0] op_sel_hi:[1,0,1] neg_lo:[1,0,0]
  v_pk_fma_f32 v[140:141], v[162:163], v[150:151], v[140:141] op_sel:[1,1,0] op_sel_hi:[1,0,1] neg_lo:[1,0,0]
  v_pk_fma_f32 v[142:143], v[162:163], v[168:169], v[142:143] op_sel:[1,1,0] op_sel_hi:[1,0,1] neg_lo:[1,0,0]
  v_cvt_pk_bf16_f32 v132, v138, v139
  ds_write_b32 v118, v132 offset:28832
  v_cvt_pk_bf16_f32 v133, v140, v141
  ds_write_b32 v118, v133 offset:29376
  v_cvt_pk_bf16_f32 v130, v142, v143
  ds_write_b32 v118, v130 offset:29920
  v_cvt_pk_bf16_f32 v131, v160, v161
  ds_write_b32 v118, v131 offset:30464
  s_branch L_kgen_done
L_roleL:
  v_subrev_u32 v5, 4096, v11
  s_waitcnt vmcnt(8)
  v_lshlrev_b32 v3, 16, v104
  v_lshlrev_b32 v4, 16, v100
  v_mul_f32 v3, 0x3fb8aa3b, v3
  v_mul_f32 v4, 0x3fb8aa3b, v4
  v_exp_f32 v3, v3
  v_exp_f32 v4, v4
  v_lshlrev_b32 v127, 16, v101
  v_lshlrev_b32 v128, 16, v102
  v_lshlrev_b32 v129, 16, v103
  v_cvt_pk_bf16_f32 v3, v4, v3
  v_lshlrev_b32 v4, 16, v3
  v_and_b32 v3, 0xffff0000, v3
  v_mul_f32 v126, v4, v3
  v_mul_f32 v127, v127, v3
  v_add_f32 v3, v3, v3
  v_mul_f32 v126, 0xbfb8aa3b, v126
  v_mul_f32 v127, 0x3e22f983, v127
  v_mul_f32 v128, v128, v3
  v_mul_f32 v129, v129, v3
  ds_write_b128 v5, v[126:129] offset:21504
  s_mov_b64 exec, 1
  ds_add_u32 v8, v10 offset:12296
  s_mov_b64 exec, -1
  v_mul_f32 v132, 0x3f800000, v126
  v_mul_f32 v133, 0x3f800000, v127
  v_mul_f32 v130, 0x42800000, v126
  v_mul_f32 v131, 0x42800000, v127
  v_exp_f32 v132, v132
  v_fract_f32 v133, v133
  v_exp_f32 v130, v130
  v_fract_f32 v131, v131
  v_cos_f32 v144, v133
  v_sin_f32 v145, v133
  v_cos_f32 v146, v131
  v_sin_f32 v147, v131
  v_mul_f32 v144, v144, v132
  v_mul_f32 v145, v145, v132
  v_mul_f32 v146, v146, v130
  v_mul_f32 v147, v147, v130
  v_pk_mul_f32 v[148:149], v[144:145], v[144:145] op_sel:[0,0] op_sel_hi:[0,1]
  v_pk_fma_f32 v[148:149], v[144:145], v[144:145], v[148:149] op_sel:[1,1,0] op_sel_hi:[1,0,1] neg_lo:[1,0,0]
  v_pk_mul_f32 v[150:151], v[146:147], v[146:147] op_sel:[0,0] op_sel_hi:[0,1]
  v_pk_fma_f32 v[150:151], v[146:147], v[146:147], v[150:151] op_sel:[1,1,0] op_sel_hi:[1,0,1] neg_lo:[1,0,0]
  v_pk_mul_f32 v[152:153], v[148:149], v[148:149] op_sel:[0,0] op_sel_hi:[0,1]
  v_pk_fma_f32 v[152:153], v[148:149], v[148:149], v[152:153] op_sel:[1,1,0] op_sel_hi:[1,0,1] neg_lo:[1,0,0]
  v_pk_mul_f32 v[154:155], v[128:129], v[150:151] op_sel:[0,0] op_sel_hi:[0,1]
  v_pk_fma_f32 v[154:155], v[128:129], v[150:151], v[154:155] op_sel:[1,1,0] op_sel_hi:[1,0,1] neg_lo:[1,0,0]
  v_pk_mul_f32 v[156:157], v[152:153], v[152:153] op_sel:[0,0] op_sel_hi:[0,1]
  v_pk_fma_f32 v[156:157], v[152:153], v[152:153], v[156:157] op_sel:[1,1,0] op_sel_hi:[1,0,1] neg_lo:[1,0,0]
  v_pk_mul_f32 v[158:159], v[144:145], v[148:149] op_sel:[0,0] op_sel_hi:[0,1]
  v_pk_fma_f32 v[158:159], v[144:145], v[148:149], v[158:159] op_sel:[1,1,0] op_sel_hi:[1,0,1] neg_lo:[1,0,0]
  v_pk_mul_f32 v[160:161], v[156:157], v[156:157] op_sel:[0,0] op_sel_hi:[0,1]
  v_pk_fma_f32 v[160:161], v[156:157], v[156:157], v[160:161] op_sel:[1,1,0] op_sel_hi:[1,0,1] neg_lo:[1,0,0]
  v_pk_mul_f32 v[162:163], v[128:129], v[152:153] op_sel:[0,0] op_sel_hi:[0,1]
  v_pk_fma_f32 v[162:163], v[128:129], v[152:153], v[162:163] op_sel:[1,1,0] op_sel_hi:[1,0,1] neg_lo:[1,0,0]
  v_pk_mul_f32 v[164:165], v[160:161], v[160:161] op_sel:[0,0] op_sel_hi:[0,1]
  v_pk_fma_f32 v[164:165], v[160:161], v[160:161], v[164:165] op_sel:[1,1,0] op_sel_hi:[1,0,1] neg_lo:[1,0,0]
  v_pk_mul_f32 v[166:167], v[154:155], v[152:153] op_sel:[0,0] op_sel_hi:[0,1]
  v_pk_fma_f32 v[166:167], v[154:155], v[152:153], v[166:167] op_sel:[1,1,0] op_sel_hi:[1,0,1] neg_lo:[1,0,0]
  v_pk_mul_f32 v[168:169], v[156:157], v[160:161] op_sel:[0,0] op_sel_hi:[0,1]
  v_pk_fma_f32 v[168:169], v[156:157], v[160:161], v[168:169] op_sel:[1,1,0] op_sel_hi:[1,0,1] neg_lo:[1,0,0]
  v_pk_mul_f32 v[170:171], v[146:147], v[164:165] op_sel:[0,0] op_sel_hi:[0,1]
  v_pk_fma_f32 v[170:171], v[146:147], v[164:165], v[170:171] op_sel:[1,1,0] op_sel_hi:[1,0,1] neg_lo:[1,0,0]
  s_mov_b32 s69, 0
L_spin3:
  ds_read_b32 v6, v8 offset:12288
  s_add_u32 s69, s69, 1
  s_waitcnt lgkmcnt(0)
  v_readfirstlane_b32 s68, v6
  s_cmp_ge_u32 s68, 1
  s_cbranch_scc1 L_spin3_go
  s_cmp_lt_u32 s69, 4000000
  s_cbranch_scc1 L_spin3
L_spin3_go:
  s_mov_b32 s60, s68
  v_mov_b32 v122, s68
  v_mov_b32 v82, v122
  v_mov_b32 v83, v122
  v_mov_b32 v86, v122
  v_mov_b32 v87, v122
  s_waitcnt vmcnt(4)
  buffer_store_dwordx4 v[80:83], v117, s[16:19], s72 offen sc1
  buffer_store_dwordx4 v[84:87], v117, s[16:19], s73 offen sc1
  v_pk_mul_f32 v[138:139], v[128:129], v[144:145] op_sel:[0,0] op_sel_hi:[0,1]
  v_pk_mul_f32 v[140:141], v[128:129], v[148:149] op_sel:[0,0] op_sel_hi:[0,1]
  v_pk_mul_f32 v[142:143], v[128:129], v[158:159] op_sel:[0,0] op_sel_hi:[0,1]
  v_cvt_pk_bf16_f32 v132, v128, v129
  ds_write_b32 v118, v132 offset:8704
  v_pk_fma_f32 v[138:139], v[128:129], v[144:145], v[138:139] op_sel:[1,1,0] op_sel_hi:[1,0,1] neg_lo:[1,0,0]
  v_pk_fma_f32 v[140:141], v[128:129], v[148:149], v[140:141] op_sel:[1,1,0] op_sel_hi:[1,0,1] neg_lo:[1,0,0]
  v_pk_fma_f32 v[142:143], v[128:129], v[158:159], v[142:143] op_sel:[1,1,0] op_sel_hi:[1,0,1] neg_lo:[1,0,0]
  v_cvt_pk_bf16_f32 v133, v138, v139
  ds_write_b32 v118, v133 offset:9248
  v_cvt_pk_bf16_f32 v130, v140, v141
  ds_write_b32 v118, v130 offset:9792
  v_cvt_pk_bf16_f32 v131, v142, v143
  ds_write_b32 v118, v131 offset:10336
  v_pk_mul_f32 v[138:139], v[162:163], v[144:145] op_sel:[0,0] op_sel_hi:[0,1]
  v_pk_mul_f32 v[140:141], v[162:163], v[148:149] op_sel:[0,0] op_sel_hi:[0,1]
  v_pk_mul_f32 v[142:143], v[162:163], v[158:159] op_sel:[0,0] op_sel_hi:[0,1]
  v_cvt_pk_bf16_f32 v132, v162, v163
  ds_write_b32 v118, v132 offset:10880
  v_pk_fma_f32 v[138:139], v[162:163], v[144:145], v[138:139] op_sel:[1,1,0] op_sel_hi:[1,0,1] neg_lo:[1,0,0]
  v_pk_fma_f32 v[140:141], v[162:163], v[148:149], v[140:141] op_sel:[1,1,0] op_sel_hi:[1,0,1] neg_lo:[1,0,0]
  v_pk_fma_f32 v[142:143], v[162:163], v[158:159], v[142:143] op_sel:[1,1,0] op_sel_hi:[1,0,1] neg_lo:[1,0,0]
  v_cvt_pk_bf16_f32 v133, v138, v139
  ds_write_b32 v118, v133 offset:11424
  v_cvt_pk_bf16_f32 v130, v140, v141
  ds_write_b32 v118, v130 offset:11968
  v_cvt_pk_bf16_f32 v131, v142, v143
  ds_write_b32 v118, v131 offset:12512
  v_pk_mul_f32 v[138:139], v[154:155], v[144:145] op_sel:[0,0] op_sel_hi:[0,1]
  v_pk_mul_f32 v[140:141], v[154:155], v[148:149] op_sel:[0,0] op_sel_hi:[0,1]
  v_pk_mul_f32 v[142:143], v[154:155], v[158:159] op_sel:[0,0] op_sel_hi:[0,1]
  v_cvt_pk_bf16_f32 v132, v154, v155
  ds_write_b32 v118, v132 offset:13056
  v_pk_fma_f32 v[138:139], v[154:155], v[144:145], v[138:139] op_sel:[1,1,0] op_sel_hi:[1,0,1] neg_lo:[1,0,0]
  v_pk_fma_f32 v[140:141], v[154:155], v[148:149], v[140:141] op_sel:[1,1,0] op_sel_hi:[1,0,1] neg_lo:[1,0,0]
  v_pk_fma_f32 v[142:143], v[154:155], v[158:159], v[142:143] op_sel:[1,1,0] op_sel_hi:[1,0,1] neg_lo:[1,0,0]
  v_cvt_pk_bf16_f32 v133, v138, v139
  ds_write_b32 v118, v133 offset:13600
  v_cvt_pk_bf16_f32 v130, v140, v141
  ds_write_b32 v118, v130 offset:14144
  v_cvt_pk_bf16_f32 v131, v142, v143
  ds_write_b32 v118, v131 offset:14688
  v_pk_mul_f32 v[138:139], v[166:167], v[144:145] op_sel:[0,0] op_sel_hi:[0,1]
  v_pk_mul_f32 v[140:141], v[166:167], v[148:149] op_sel:[0,0] op_sel_hi:[0,1]
  v_pk_mul_f32 v[142:143], v[166:167], v[158:159] op_sel:[0,0] op_sel_hi:[0,1]
  v_cvt_pk_bf16_f32 v132, v166, v167
  ds_write_b32 v118, v132 offset:15232
  v_pk_fma_f32 v[138:139], v[166:167], v[144:145], v[138:139] op_sel:[1,1,0] op_sel_hi:[1,0,1] neg_lo:[1,0,0]
  v_pk_fma_f32 v[140:141], v[166:167], v[148:149], v[140:141] op_sel:[1,1,0] op_sel_hi:[1,0,1] neg_lo:[1,0,0]
  v_pk_fma_f32 v[142:143], v[166:167], v[158:159], v[142:143] op_sel:[1,1,0] op_sel_hi:[1,0,1] neg_lo:[1,0,0]
  v_cvt_pk_bf16_f32 v133, v138, v139
  ds_write_b32 v118, v133 offset:15776
  v_cvt_pk_bf16_f32 v130, v140, v141
  ds_write_b32 v118, v130 offset:16320
  v_cvt_pk_bf16_f32 v131, v142, v143
  ds_write_b32 v118, v131 offset:16864
  s_lshl_b32 s68, s58, 2
  s_add_u32 s68, s68, s101
  s_lshl_b32 s69, s68, 2
  v_bfe_u32 v4, v1, 3, 2
  v_add_u32 v4, s69, v4
  v_mul_u32_u24 v4, 3584, v4
  v_and_b32 v5, 7, v1
  v_lshl_add_u32 v4, v5, 6, v4
  s_mul_i32 s69, s57, 448
  s_and_b32 s69, s69, 0xffffff80
  s_mov_b32 exec_lo, 0xffffffff
  s_mov_b32 exec_hi, 0
  buffer_load_dword v70, v4, s[44:47], s69 offen
  s_mov_b64 exec, -1
  v_mov_b32 v132, 0x3f80
  ds_write_b32 v118, v132 offset:0
  v_cvt_pk_bf16_f32 v133, v156, -v157
  ds_write_b32 v118, v133 offset:544
  v_cvt_pk_bf16_f32 v130, v160, -v161
  ds_write_b32 v118, v130 offset:1088
  v_cvt_pk_bf16_f32 v131, v168, -v169
  ds_write_b32 v118, v131 offset:1632
  v_pk_mul_f32 v[138:139], v[164:165], v[156:157] op_sel:[0,0] op_sel_hi:[0,1]
  v_pk_mul_f32 v[140:141], v[164:165], v[160:161] op_sel:[0,0] op_sel_hi:[0,1]
  v_pk_mul_f32 v[142:143], v[164:165], v[168:169] op_sel:[0,0] op_sel_hi:[0,1]
  v_cvt_pk_bf16_f32 v132, v164, -v165
  ds_write_b32 v118, v132 offset:2176
  v_pk_fma_f32 v[138:139], v[164:165], v[156:157], v[138:139] op_sel:[1,1,0] op_sel_hi:[1,0,1] neg_lo:[1,0,0]
  v_pk_fma_f32 v[140:141], v[164:165], v[160:161], v[140:141] op_sel:[1,1,0] op_sel_hi:[1,0,1] neg_lo:[1,0,0]
  v_pk_fma_f32 v[142:143], v[164:165], v[168:169], v[142:143] op_sel:[1,1,0] op_sel_hi:[1,0,1] neg_lo:[1,0,0]
  v_cvt_pk_bf16_f32 v133, v138, -v139
  ds_write_b32 v118, v133 offset:2720
  v_cvt_pk_bf16_f32 v130, v140, -v141
  ds_write_b32 v118, v130 offset:3264
  v_cvt_pk_bf16_f32 v131, v142, -v143
  ds_write_b32 v118, v131 offset:3808
  v_pk_mul_f32 v[138:139], v[146:147], v[156:157] op_sel:[0,0] op_sel_hi:[0,1]
  v_pk_mul_f32 v[140:141], v[146:147], v[160:161] op_sel:[0,0] op_sel_hi:[0,1]
  v_pk_mul_f32 v[142:143], v[146:147], v[168:169] op_sel:[0,0] op_sel_hi:[0,1]
  v_cvt_pk_bf16_f32 v132, v146, -v147
  ds_write_b32 v118, v132 offset:4352
  v_pk_fma_f32 v[138:139], v[146:147], v[156:157], v[138:139] op_sel:[1,1,0] op_sel_hi:[1,0,1] neg_lo:[1,0,0]
  v_pk_fma_f32 v[140:141], v[146:147], v[160:161], v[140:141] op_sel:[1,1,0] op_sel_hi:[1,0,1] neg_lo:[1,0,0]
  v_pk_fma_f32 v[142:143], v[146:147], v[168:169], v[142:143] op_sel:[1,1,0] op_sel_hi:[1,0,1] neg_lo:[1,0,0]
  v_cvt_pk_bf16_f32 v133, v138, -v139
  ds_write_b32 v118, v133 offset:4896
  v_cvt_pk_bf16_f32 v130, v140, -v141
  ds_write_b32 v118, v130 offset:5440
  v_cvt_pk_bf16_f32 v131, v142, -v143
  ds_write_b32 v118, v131 offset:5984
  v_pk_mul_f32 v[138:139], v[170:171], v[156:157] op_sel:[0,0] op_sel_hi:[0,1]
  v_pk_mul_f32 v[140:141], v[170:171], v[160:161] op_sel:[0,0] op_sel_hi:[0,1]
  v_pk_mul_f32 v[142:143], v[170:171], v[168:169] op_sel:[0,0] op_sel_hi:[0,1]
  v_cvt_pk_bf16_f32 v132, v170, -v171
  ds_write_b32 v118, v132 offset:6528
  v_pk_fma_f32 v[138:139], v[170:171], v[156:157], v[138:139] op_sel:[1,1,0] op_sel_hi:[1,0,1] neg_lo:[1,0,0]
  v_pk_fma_f32 v[140:141], v[170:171], v[160:161], v[140:141] op_sel:[1,1,0] op_sel_hi:[1,0,1] neg_lo:[1,0,0]
  v_pk_fma_f32 v[142:143], v[170:171], v[168:169], v[142:143] op_sel:[1,1,0] op_sel_hi:[1,0,1] neg_lo:[1,0,0]
  v_cvt_pk_bf16_f32 v133, v138, -v139
  ds_write_b32 v118, v133 offset:7072
  v_cvt_pk_bf16_f32 v130, v140, -v141
  ds_write_b32 v118, v130 offset:7616
  v_cvt_pk_bf16_f32 v131, v142, -v143
  ds_write_b32 v118, v131 offset:8160
  s_lshl_b32 s68, s58, 2
  s_add_u32 s68, s68, s101
  s_mul_i32 s69, s68, 28
  v_add_u32 v4, s69, v1
  v_lshlrev_b32 v4, 6, v4
  s_mul_i32 s69, s57, 229376
  s_mov_b64 exec, 0xfffffff
  buffer_load_dword v69, v4, s[48:51], s69 offen
  s_mov_b64 exec, -1
L_kgen_done:
  s_waitcnt lgkmcnt(0)
  s_barrier
  s_cmp_ge_u32 s56, 6
  s_cbranch_scc1 L_w67
  ds_read_b128 v[148:151], v119 offset:0
  ds_read_b128 v[180:183], v120 offset:0
  ds_read_b128 v[152:155], v119 offset:64
  ds_read_b128 v[184:187], v120 offset:64
  ds_read_b128 v[156:159], v119 offset:128
  ds_read_b128 v[188:191], v120 offset:128
  ds_read_b128 v[160:163], v119 offset:192
  ds_read_b128 v[192:195], v120 offset:192
  ds_read_b128 v[164:167], v119 offset:256
  ds_read_b128 v[196:199], v120 offset:256
  ds_read_b128 v[168:171], v119 offset:320
  ds_read_b128 v[200:203], v120 offset:320
  s_waitcnt lgkmcnt(10)
  v_mfma_f32_16x16x32_bf16 v[144:147], v[148:151], v[180:183], 0
  ds_read_b128 v[172:175], v119 offset:384
  ds_read_b128 v[204:207], v120 offset:384
  s_waitcnt lgkmcnt(10)
  v_mfma_f32_16x16x32_bf16 v[144:147], v[152:155], v[184:187], v[144:147]
  ds_read_b128 v[176:179], v119 offset:448
  ds_read_b128 v[208:211], v120 offset:448
  s_waitcnt lgkmcnt(10)
  v_mfma_f32_16x16x32_bf16 v[144:147], v[156:159], v[188:191], v[144:147]
  s_waitcnt lgkmcnt(8)
  v_mfma_f32_16x16x32_bf16 v[144:147], v[160:163], v[192:195], v[144:147]
  s_waitcnt lgkmcnt(6)
  v_mfma_f32_16x16x32_bf16 v[144:147], v[164:167], v[196:199], v[144:147]
  s_waitcnt lgkmcnt(4)
  v_mfma_f32_16x16x32_bf16 v[144:147], v[168:171], v[200:203], v[144:147]
  s_waitcnt lgkmcnt(2)
  v_mfma_f32_16x16x32_bf16 v[144:147], v[172:175], v[204:207], v[144:147]
  s_waitcnt lgkmcnt(0)
  v_mfma_f32_16x16x32_bf16 v[144:147], v[176:179], v[208:211], v[144:147]
  s_nop 7
  v_cvt_pk_bf16_f32 v212, v144, v145
  v_cvt_pk_bf16_f32 v213, v146, v147
  ds_write_b64 v121, v[212:213]
  s_mov_b64 exec, 1
  ds_add_u32 v8, v10 offset:12300
  s_mov_b64 exec, -1
  s_branch L_nokt
L_w67:
  s_waitcnt vmcnt(4)
  s_cmp_ge_u32 s58, 14
  s_cbranch_scc1 L_nokt
  s_lshl_b32 s68, s100, 14
  s_and_b32 s69, s56, 1
  s_lshl_b32 s3, s69, 13
  s_add_u32 s68, s68, s3
  s_lshl_b32 s69, s69, 14
  s_add_u32 m0, s69, 99328
  s_nop 0
  buffer_load_dwordx4 v7, s[48:51], s68 offen lds
  s_add_u32 m0, m0, 1024
  s_add_u32 s68, s68, 1024
  buffer_load_dwordx4 v7, s[48:51], s68 offen lds
  s_add_u32 m0, m0, 1024
  s_add_u32 s68, s68, 1024
  buffer_load_dwordx4 v7, s[48:51], s68 offen lds
  s_add_u32 m0, m0, 1024
  s_add_u32 s68, s68, 1024
  buffer_load_dwordx4 v7, s[48:51], s68 offen lds
  s_add_u32 m0, m0, 5120
  s_add_u32 s68, s68, 1024
  buffer_load_dwordx4 v7, s[48:51], s68 offen lds
  s_add_u32 m0, m0, 1024
  s_add_u32 s68, s68, 1024
  buffer_load_dwordx4 v7, s[48:51], s68 offen lds
  s_add_u32 m0, m0, 1024
  s_add_u32 s68, s68, 1024
  buffer_load_dwordx4 v7, s[48:51], s68 offen lds
  s_add_u32 m0, m0, 1024
  s_add_u32 s68, s68, 1024
  buffer_load_dwordx4 v7, s[48:51], s68 offen lds
L_nokt:
  s_cmp_ge_u32 s56, 4
  s_cbranch_scc1 L_noE
  v_and_b32 v3, 3, v15
  v_mul_u32_u24 v3, 4160, v3
  v_lshrrev_b32 v4, 2, v15
  v_lshlrev_b32 v4, 3, v4
  v_sub_u32 v3, v3, v4
  v_lshl_add_u32 v3, v16, 4, v3
  s_mul_i32 s78, s66, 16640
  s_lshl_b32 s79, s65, 8
  s_sub_u32 s78, s78, s79
  s_add_u32 s78, s78, 25880
  v_add_u32 v17, s78, v3
  s_mul_i32 s78, s66, 6144
  s_sub_u32 s78, s78, s79
  s_add_u32 s78, s78, 1824
  v_lshlrev_b32 v4, 5, v15
  v_lshl_add_u32 v4, v16, 4, v4
  v_add_u32 v18, s78, v4
  v_lshrrev_b32 v4, 1, v15
  v_add_u32 v4, v4, v16
  v_and_b32 v4, 3, v4
  v_lshlrev_b32 v4, 4, v4
  v_lshl_add_u32 v4, v15, 6, v4
  s_lshl_b32 s78, s56, 13
  s_add_u32 s78, s78, 95232
  v_add_u32 v19, s78, v4
L_noE:
  s_lshr_b32 s68, s56, 2
  s_mul_i32 s68, s68, 16640
  s_add_u32 s68, s68, 25600
  v_and_b32 v3, 0xfff, v11
  v_add_u32 v123, s68, v3
  v_bfe_u32 v4, v1, 1, 2
  v_mul_u32_u24 v4, 4160, v4
  v_and_b32 v5, 1, v1
  v_lshl_add_u32 v4, v5, 4, v4
  s_add_u32 s68, s68, 4096
  v_add_u32 v124, s68, v4
  s_cmp_ge_u32 s56, 6
  s_cbranch_scc1 L_ixd
  s_waitcnt vmcnt(4)
L_ixd:
  v_and_b32 v142, 0xffff, v106
  v_lshrrev_b32 v143, 16, v106
  v_and_b32 v144, 0xffff, v107
  v_lshrrev_b32 v145, 16, v107
  v_and_b32 v146, 0xffff, v108
  v_lshrrev_b32 v147, 16, v108
  v_and_b32 v148, 0xffff, v109
  v_lshrrev_b32 v149, 16, v109
  v_and_b32 v150, 0xffff, v110
  v_lshrrev_b32 v151, 16, v110
  v_and_b32 v152, 0xffff, v111
  s_mov_b32 s69, 0
L_spin4:
  ds_read_b32 v6, v8 offset:12300
  s_add_u32 s69, s69, 1
  s_waitcnt lgkmcnt(0)
  v_readfirstlane_b32 s68, v6
  s_cmp_ge_u32 s68, 6
  s_cbranch_scc1 L_spin4_go
  s_cmp_lt_u32 s69, 4000000
  s_cbranch_scc1 L_spin4
L_spin4_go:
  buffer_load_dwordx4 v[126:129], v13, s[16:19], s74 offen sc1
  buffer_load_dwordx4 v[130:133], v13, s[16:19], s75 offen sc1
  buffer_load_dwordx4 v[134:137], v11, s[16:19], s76 offen sc1
  buffer_load_dwordx4 v[138:141], v11, s[16:19], s77 offen sc1
  ds_read_u16 v153, v142
  ds_read_u16 v154, v143
  ds_read_u16 v155, v144
  ds_read_u16 v156, v145
  ds_read_u16 v157, v146
  ds_read_u16 v158, v147
  ds_read_u16 v159, v148
  ds_read_u16 v160, v149
  ds_read_u16 v161, v150
  ds_read_u16 v162, v151
  ds_read_u16 v163, v152
  s_waitcnt lgkmcnt(3)
  v_lshl_or_b32 v164, v154, 16, v153
  v_lshl_or_b32 v165, v156, 16, v155
  v_lshl_or_b32 v166, v158, 16, v157
  v_lshl_or_b32 v167, v160, 16, v159
  ds_write_b128 v123, v[164:167] offset:12480
  s_waitcnt lgkmcnt(1)
  v_lshl_or_b32 v172, v155, 16, v154
  v_lshl_or_b32 v173, v157, 16, v156
  v_lshl_or_b32 v174, v159, 16, v158
  v_lshl_or_b32 v175, v161, 16, v160
  ds_write_b128 v123, v[172:175] offset:8320
  v_lshl_or_b32 v168, v156, 16, v155
  v_lshl_or_b32 v169, v158, 16, v157
  v_lshl_or_b32 v170, v160, 16, v159
  v_lshl_or_b32 v171, v162, 16, v161
  ds_write_b128 v123, v[168:171] offset:4160
  v_lshl_or_b32 v176, v157, 16, v156
  v_lshl_or_b32 v177, v159, 16, v158
  v_lshl_or_b32 v178, v161, 16, v160
  v_lshl_or_b32 v179, v163, 16, v162
  ds_write_b128 v123, v[176:179] offset:0
  s_and_b32 s68, s56, 3
  s_cmp_lg_u32 s68, 0
  s_cbranch_scc1 L_nozc
  v_mov_b32 v164, 0
  v_mov_b32 v165, 0
  v_mov_b32 v166, 0
  v_mov_b32 v167, 0
  s_mov_b64 exec, 0xff
  ds_write_b128 v124, v[164:167]
  s_mov_b64 exec, -1
L_nozc:
L_p4:
  s_mov_b32 s61, 0
L_xpoll:
  s_waitcnt vmcnt(0)
L_xchk:
  v_cmp_ne_u32 vcc, s60, v129
  v_cmp_ne_u32 s[78:79], s60, v133
  v_cmp_ne_u32 s[80:81], s60, v137
  v_cmp_ne_u32 s[82:83], s60, v141
  s_or_b64 vcc, vcc, s[78:79]
  s_or_b64 s[80:81], s[80:81], s[82:83]
  s_or_b64 vcc, vcc, s[80:81]
  s_cbranch_vccz L_xok
  s_add_u32 s61, s61, 1
  s_cmp_ge_u32 s61, 100000
  s_cbranch_scc1 L_xok
  buffer_load_dwordx4 v[126:129], v13, s[16:19], s74 offen sc1
  buffer_load_dwordx4 v[130:133], v13, s[16:19], s75 offen sc1
  buffer_load_dwordx4 v[134:137], v11, s[16:19], s76 offen sc1
  buffer_load_dwordx4 v[138:141], v11, s[16:19], s77 offen sc1
  s_branch L_xpoll
L_xok:
  v_and_b32 v146, 0xffff0000, v134
  v_rcp_f32 v146, v146
  v_lshlrev_b32 v142, 16, v134
  v_and_b32 v147, 0xffff0000, v135
  v_rcp_f32 v147, v147
  v_lshlrev_b32 v143, 16, v135
  v_and_b32 v148, 0xffff0000, v138
  v_rcp_f32 v148, v148
  v_lshlrev_b32 v144, 16, v138
  v_and_b32 v149, 0xffff0000, v139
  v_rcp_f32 v149, v149
  v_lshlrev_b32 v145, 16, v139
  v_lshlrev_b32 v22, 16, v126
  v_and_b32 v23, 0xffff0000, v126
  v_mul_f32 v142, v142, v146
  v_lshlrev_b32 v24, 16, v127
  v_and_b32 v25, 0xffff0000, v127
  v_mul_f32 v143, v143, v147
  v_lshlrev_b32 v26, 16, v130
  v_and_b32 v27, 0xffff0000, v130
  v_mul_f32 v144, v144, v148
  v_lshlrev_b32 v28, 16, v131
  v_and_b32 v29, 0xffff0000, v131
  v_mul_f32 v145, v145, v149
  v_fma_f32 v30, v22, v146, -v142
  v_fma_f32 v31, v23, v146, -v142
  v_fma_f32 v32, v24, v147, -v143
  v_fma_f32 v33, v25, v147, -v143
  v_fma_f32 v34, v26, v148, -v144
  v_fma_f32 v35, v27, v148, -v144
  v_fma_f32 v36, v28, v149, -v145
  v_fma_f32 v37, v29, v149, -v145
  v_cvt_pk_bf16_f32 v150, v30, v32
  ds_write_b32 v14, v150 offset:0
  v_cvt_pk_bf16_f32 v151, v31, v33
  ds_write_b32 v14, v151 offset:6144
  v_cvt_pk_bf16_f32 v152, v34, v36
  ds_write_b32 v14, v152 offset:2048
  v_cvt_pk_bf16_f32 v153, v35, v37
  ds_write_b32 v14, v153 offset:8192
  v_lshlrev_b32 v3, 3, v0
  v_lshlrev_b32 v4, 1, v0
  v_sub_u32 v4, 0xffff, v4
  v_lshlrev_b32 v154, 16, v136
  v_subrev_u32 v5, 0, v4
  v_or_b32 v154, v154, v5
  v_and_b32 v155, 0xffff0000, v136
  v_subrev_u32 v5, 1, v4
  v_or_b32 v155, v155, v5
  v_lshlrev_b32 v156, 16, v140
  v_subrev_u32 v5, 1024, v4
  v_or_b32 v156, v156, v5
  v_and_b32 v157, 0xffff0000, v140
  v_subrev_u32 v5, 1025, v4
  v_or_b32 v157, v157, v5
  v_max_f32 v158, v154, v155
  v_min_f32 v159, v154, v155
  v_max_f32 v5, v156, v157
  v_min_f32 v6, v156, v157
  v_max_f32 v159, v159, v6
  v_med3_f32 v159, v158, v5, v159
  v_max_f32 v158, v158, v5
  ds_write_b64 v3, v[158:159] offset:21504
  ds_write_b64 v3, v[134:135] offset:13312
  ds_write_b64 v3, v[138:139] offset:17408
  s_waitcnt lgkmcnt(0)
  s_barrier
  s_cmp_ge_u32 s56, 4
  s_cbranch_scc1 L_helper
  ds_read_b64 v[176:177], v17 offset:2240
  ds_read_b64 v[178:179], v17 offset:2248
  ds_read_b128 v[112:115], v18 offset:192
  ds_read_b64 v[180:181], v17 offset:2752
  ds_read_b64 v[182:183], v17 offset:2760
  ds_read_b128 v[116:119], v18 offset:704
  ds_read_b64 v[184:185], v17 offset:3264
  ds_read_b64 v[186:187], v17 offset:3272
  ds_read_b128 v[120:123], v18 offset:1216
  s_waitcnt lgkmcnt(6)
  v_mfma_f32_16x16x32_bf16 v[92:95], v[176:179], v[112:115], 0
  ds_read_b64 v[188:189], v17 offset:3776
  ds_read_b64 v[190:191], v17 offset:3784
  s_waitcnt lgkmcnt(6)
  v_mfma_f32_16x16x32_bf16 v[88:91], v[180:183], v[112:115], 0
  ds_read_b128 v[124:127], v18 offset:1728
  s_waitcnt lgkmcnt(6)
  v_mfma_f32_16x16x32_bf16 v[92:95], v[180:183], v[116:119], v[92:95]
  ds_read_b64 v[192:193], v17 offset:2176
  ds_read_b64 v[194:195], v17 offset:2184
  s_waitcnt lgkmcnt(6)
  v_mfma_f32_16x16x32_bf16 v[84:87], v[184:187], v[112:115], 0
  ds_read_b128 v[144:147], v18 offset:128
  v_mfma_f32_16x16x32_bf16 v[88:91], v[184:187], v[116:119], v[88:91]
  ds_read_b64 v[196:197], v17 offset:2688
  ds_read_b64 v[198:199], v17 offset:2696
  s_waitcnt lgkmcnt(8)
  v_mfma_f32_16x16x32_bf16 v[92:95], v[184:187], v[120:123], v[92:95]
  ds_read_b128 v[148:151], v18 offset:640
  s_waitcnt lgkmcnt(7)
  v_mfma_f32_16x16x32_bf16 v[80:83], v[188:191], v[112:115], 0
  ds_read_b64 v[200:201], v17 offset:3200
  ds_read_b64 v[202:203], v17 offset:3208
  v_mfma_f32_16x16x32_bf16 v[84:87], v[188:191], v[116:119], v[84:87]
  ds_read_b128 v[152:155], v18 offset:1152
  v_mfma_f32_16x16x32_bf16 v[88:91], v[188:191], v[120:123], v[88:91]
  ds_read_b64 v[204:205], v17 offset:3712
  ds_read_b64 v[206:207], v17 offset:3720
  s_waitcnt lgkmcnt(11)
  v_mfma_f32_16x16x32_bf16 v[92:95], v[188:191], v[124:127], v[92:95]
  ds_read_b128 v[156:159], v18 offset:1664
  s_waitcnt lgkmcnt(9)
  v_mfma_f32_16x16x32_bf16 v[92:95], v[192:195], v[144:147], v[92:95]
  ds_read_b64 v[176:177], v17 offset:2112
  ds_read_b64 v[178:179], v17 offset:2120
  s_waitcnt lgkmcnt(9)
  v_mfma_f32_16x16x32_bf16 v[88:91], v[196:199], v[144:147], v[88:91]
  ds_read_b128 v[112:115], v18 offset:64
  s_waitcnt lgkmcnt(9)
  v_mfma_f32_16x16x32_bf16 v[92:95], v[196:199], v[148:151], v[92:95]
  ds_read_b64 v[180:181], v17 offset:2624
  ds_read_b64 v[182:183], v17 offset:2632
  s_waitcnt lgkmcnt(9)
  v_mfma_f32_16x16x32_bf16 v[84:87], v[200:203], v[144:147], v[84:87]
  ds_read_b128 v[116:119], v18 offset:576
  v_mfma_f32_16x16x32_bf16 v[88:91], v[200:203], v[148:151], v[88:91]
  ds_read_b64 v[184:185], v17 offset:3136
  ds_read_b64 v[186:187], v17 offset:3144
  s_waitcnt lgkmcnt(11)
  v_mfma_f32_16x16x32_bf16 v[92:95], v[200:203], v[152:155], v[92:95]
  ds_read_b128 v[120:123], v18 offset:1088
  s_waitcnt lgkmcnt(10)
  v_mfma_f32_16x16x32_bf16 v[80:83], v[204:207], v[144:147], v[80:83]
  ds_read_b64 v[188:189], v17 offset:3648
  ds_read_b64 v[190:191], v17 offset:3656
  v_mfma_f32_16x16x32_bf16 v[84:87], v[204:207], v[148:151], v[84:87]
  ds_read_b128 v[124:127], v18 offset:1600
  v_mfma_f32_16x16x32_bf16 v[88:91], v[204:207], v[152:155], v[88:91]
  s_waitcnt lgkmcnt(12)
  v_mfma_f32_16x16x32_bf16 v[92:95], v[204:207], v[156:159], v[92:95]
  s_waitcnt lgkmcnt(9)
  v_mfma_f32_16x16x32_bf16 v[92:95], v[176:179], v[112:115], v[92:95]
  ds_read_b64 v[192:193], v17 offset:2048
  ds_read_b64 v[194:195], v17 offset:2056
  s_waitcnt lgkmcnt(9)
  v_mfma_f32_16x16x32_bf16 v[88:91], v[180:183], v[112:115], v[88:91]
  ds_read_b128 v[144:147], v18 offset:0
  s_waitcnt lgkmcnt(9)
  v_mfma_f32_16x16x32_bf16 v[92:95], v[180:183], v[116:119], v[92:95]
  ds_read_b64 v[196:197], v17 offset:2560
  ds_read_b64 v[198:199], v17 offset:2568
  s_waitcnt lgkmcnt(9)
  v_mfma_f32_16x16x32_bf16 v[84:87], v[184:187], v[112:115], v[84:87]
  ds_read_b128 v[148:151], v18 offset:512
  v_mfma_f32_16x16x32_bf16 v[88:91], v[184:187], v[116:119], v[88:91]
  ds_read_b64 v[200:201], v17 offset:3072
  ds_read_b64 v[202:203], v17 offset:3080
  s_waitcnt lgkmcnt(11)
  v_mfma_f32_16x16x32_bf16 v[92:95], v[184:187], v[120:123], v[92:95]
  ds_read_b128 v[152:155], v18 offset:1024
  s_waitcnt lgkmcnt(10)
  v_mfma_f32_16x16x32_bf16 v[80:83], v[188:191], v[112:115], v[80:83]
  ds_read_b64 v[204:205], v17 offset:3584
  ds_read_b64 v[206:207], v17 offset:3592
  v_mfma_f32_16x16x32_bf16 v[84:87], v[188:191], v[116:119], v[84:87]
  ds_read_b128 v[156:159], v18 offset:1536
  v_mfma_f32_16x16x32_bf16 v[88:91], v[188:191], v[120:123], v[88:91]
  s_waitcnt lgkmcnt(12)
  v_mfma_f32_16x16x32_bf16 v[92:95], v[188:191], v[124:127], v[92:95]
  s_waitcnt lgkmcnt(9)
  v_mfma_f32_16x16x32_bf16 v[92:95], v[192:195], v[144:147], v[92:95]
  ds_read_b64 v[176:177], v17 offset:192
  ds_read_b64 v[178:179], v17 offset:200
  s_waitcnt lgkmcnt(9)
  v_mfma_f32_16x16x32_bf16 v[88:91], v[196:199], v[144:147], v[88:91]
  ds_read_b128 v[112:115], v18 offset:192
  s_waitcnt lgkmcnt(9)
  v_mfma_f32_16x16x32_bf16 v[92:95], v[196:199], v[148:151], v[92:95]
  ds_read_b64 v[180:181], v17 offset:704
  ds_read_b64 v[182:183], v17 offset:712
  s_waitcnt lgkmcnt(9)
  v_mfma_f32_16x16x32_bf16 v[84:87], v[200:203], v[144:147], v[84:87]
  ds_read_b128 v[116:119], v18 offset:704
  v_mfma_f32_16x16x32_bf16 v[88:91], v[200:203], v[148:151], v[88:91]
  ds_read_b64 v[184:185], v17 offset:1216
  ds_read_b64 v[186:187], v17 offset:1224
  s_waitcnt lgkmcnt(11)
  v_mfma_f32_16x16x32_bf16 v[92:95], v[200:203], v[152:155], v[92:95]
  ds_read_b128 v[120:123], v18 offset:1216
  s_waitcnt lgkmcnt(10)
  v_mfma_f32_16x16x32_bf16 v[80:83], v[204:207], v[144:147], v[80:83]
  ds_read_b64 v[188:189], v17 offset:1728
  ds_read_b64 v[190:191], v17 offset:1736
  v_mfma_f32_16x16x32_bf16 v[84:87], v[204:207], v[148:151], v[84:87]
  ds_read_b128 v[124:127], v18 offset:1728
  v_mfma_f32_16x16x32_bf16 v[88:91], v[204:207], v[152:155], v[88:91]
  s_waitcnt lgkmcnt(12)
  v_mfma_f32_16x16x32_bf16 v[92:95], v[204:207], v[156:159], v[92:95]
  s_waitcnt lgkmcnt(9)
  v_mfma_f32_16x16x32_bf16 v[108:111], v[176:179], v[112:115], 0
  ds_read_b64 v[192:193], v17 offset:2240
  ds_read_b64 v[194:195], v17 offset:2248
  s_waitcnt lgkmcnt(9)
  v_mfma_f32_16x16x32_bf16 v[104:107], v[180:183], v[112:115], 0
  ds_read_b128 v[128:131], v18 offset:2240
  s_waitcnt lgkmcnt(9)
  v_mfma_f32_16x16x32_bf16 v[108:111], v[180:183], v[116:119], v[108:111]
  ds_read_b64 v[196:197], v17 offset:2752
  ds_read_b64 v[198:199], v17 offset:2760
  s_waitcnt lgkmcnt(9)
  v_mfma_f32_16x16x32_bf16 v[100:103], v[184:187], v[112:115], 0
  ds_read_b128 v[132:135], v18 offset:2752
  v_mfma_f32_16x16x32_bf16 v[104:107], v[184:187], v[116:119], v[104:107]
  ds_write_b128 v19, v[80:83] offset:0
  ds_read_b64 v[200:201], v17 offset:3264
  ds_read_b64 v[202:203], v17 offset:3272
  s_waitcnt lgkmcnt(12)
  v_mfma_f32_16x16x32_bf16 v[108:111], v[184:187], v[120:123], v[108:111]
  ds_write_b128 v19, v[84:87] offset:1024
  s_waitcnt lgkmcnt(11)
  v_mfma_f32_16x16x32_bf16 v[96:99], v[188:191], v[112:115], 0
  ds_write_b128 v19, v[88:91] offset:2048
  ds_read_b128 v[136:139], v18 offset:3264
  v_mfma_f32_16x16x32_bf16 v[100:103], v[188:191], v[116:119], v[100:103]
  ds_write_b128 v19, v[92:95] offset:3072
  v_mfma_f32_16x16x32_bf16 v[104:107], v[188:191], v[120:123], v[104:107]
  s_mov_b64 exec, 1
  ds_add_u32 v8, v10 offset:12308
  s_mov_b64 exec, -1
  s_waitcnt lgkmcnt(14)
  v_mfma_f32_16x16x32_bf16 v[108:111], v[188:191], v[124:127], v[108:111]
  v_lshlrev_b32 v63, 16, v68
  v_and_b32 v64, 0xffff0000, v68
  s_waitcnt lgkmcnt(12)
  v_mfma_f32_16x16x32_bf16 v[96:99], v[192:195], v[116:119], v[96:99]
  v_add_f32 v63, 1.0, v63
  v_add_f32 v64, 1.0, v64
  v_mfma_f32_16x16x32_bf16 v[100:103], v[192:195], v[120:123], v[100:103]
  v_fma_f32 v38, v30, v63, v22
  v_fma_f32 v39, v31, v64, v23
  v_mfma_f32_16x16x32_bf16 v[104:107], v[192:195], v[124:127], v[104:107]
  v_fma_f32 v40, v32, v63, v24
  v_fma_f32 v41, v33, v64, v25
  s_waitcnt lgkmcnt(11)
  v_mfma_f32_16x16x32_bf16 v[108:111], v[192:195], v[128:131], v[108:111]
  v_fma_f32 v42, v34, v63, v26
  v_fma_f32 v43, v35, v64, v27
  ds_read_b64 v[204:205], v17 offset:3776
  ds_read_b64 v[206:207], v17 offset:3784
  s_waitcnt lgkmcnt(11)
  v_mfma_f32_16x16x32_bf16 v[96:99], v[196:199], v[120:123], v[96:99]
  v_fma_f32 v44, v36, v63, v28
  v_fma_f32 v45, v37, v64, v29
  ds_read_b128 v[140:143], v18 offset:3776
  v_mfma_f32_16x16x32_bf16 v[100:103], v[196:199], v[124:127], v[100:103]
  v_lshlrev_b32 v60, 11, v0
  v_lshlrev_b32 v65, 1, v0
  v_mfma_f32_16x16x32_bf16 v[104:107], v[196:199], v[128:131], v[104:107]
  v_mov_b32 v66, 0x7ff00000
  v_add_u32 v67, 58880, v11
  s_waitcnt lgkmcnt(11)
  v_mfma_f32_16x16x32_bf16 v[108:111], v[196:199], v[132:135], v[108:111]
  ds_read_b64 v[176:177], v17 offset:128
  ds_read_b64 v[178:179], v17 offset:136
  s_waitcnt lgkmcnt(10)
  v_mfma_f32_16x16x32_bf16 v[96:99], v[200:203], v[124:127], v[96:99]
  ds_read_b128 v[144:147], v18 offset:128
  v_mfma_f32_16x16x32_bf16 v[100:103], v[200:203], v[128:131], v[100:103]
  ds_read_b64 v[180:181], v17 offset:640
  ds_read_b64 v[182:183], v17 offset:648
  v_mfma_f32_16x16x32_bf16 v[104:107], v[200:203], v[132:135], v[104:107]
  s_waitcnt lgkmcnt(10)
  v_mfma_f32_16x16x32_bf16 v[108:111], v[200:203], v[136:139], v[108:111]
  ds_read_b128 v[148:151], v18 offset:640
  s_waitcnt lgkmcnt(7)
  v_mfma_f32_16x16x32_bf16 v[96:99], v[204:207], v[128:131], v[96:99]
  ds_read_b64 v[184:185], v17 offset:1152
  ds_read_b64 v[186:187], v17 offset:1160
  v_mfma_f32_16x16x32_bf16 v[100:103], v[204:207], v[132:135], v[100:103]
  ds_read_b128 v[152:155], v18 offset:1152
  v_mfma_f32_16x16x32_bf16 v[104:107], v[204:207], v[136:139], v[104:107]
  ds_read_b64 v[188:189], v17 offset:1664
  ds_read_b64 v[190:191], v17 offset:1672
  s_waitcnt lgkmcnt(11)
  v_mfma_f32_16x16x32_bf16 v[108:111], v[204:207], v[140:143], v[108:111]
  ds_read_b32 v6, v8 offset:12308
  ds_read_b128 v[156:159], v18 offset:1664
  s_waitcnt lgkmcnt(10)
  v_mfma_f32_16x16x32_bf16 v[108:111], v[176:179], v[144:147], v[108:111]
  ds_read_b64 v[192:193], v17 offset:2176
  ds_read_b64 v[194:195], v17 offset:2184
  s_waitcnt lgkmcnt(10)
  v_mfma_f32_16x16x32_bf16 v[104:107], v[180:183], v[144:147], v[104:107]
  ds_read_b128 v[160:163], v18 offset:2176
  s_waitcnt lgkmcnt(10)
  v_mfma_f32_16x16x32_bf16 v[108:111], v[180:183], v[148:151], v[108:111]
  ds_read_b64 v[196:197], v17 offset:2688
  ds_read_b64 v[198:199], v17 offset:2696
  s_waitcnt lgkmcnt(10)
  v_mfma_f32_16x16x32_bf16 v[100:103], v[184:187], v[144:147], v[100:103]
  ds_read_b128 v[164:167], v18 offset:2688
  v_mfma_f32_16x16x32_bf16 v[104:107], v[184:187], v[148:151], v[104:107]
  ds_read_b64 v[200:201], v17 offset:3200
  ds_read_b64 v[202:203], v17 offset:3208
  s_waitcnt lgkmcnt(12)
  v_mfma_f32_16x16x32_bf16 v[108:111], v[184:187], v[152:155], v[108:111]
  s_waitcnt lgkmcnt(9)
  v_readfirstlane_b32 s68, v6
  s_cmp_ge_u32 s68, 6
  s_cbranch_scc0 L_slowA
L_backA:
  ds_read_b128 v[56:59], v8 offset:12336
  ds_read_b128 v[168:171], v18 offset:3200
  v_mfma_f32_16x16x32_bf16 v[96:99], v[188:191], v[144:147], v[96:99]
  ds_read_b64 v[46:47], v20 offset:0
  v_mfma_f32_16x16x32_bf16 v[100:103], v[188:191], v[148:151], v[100:103]
  ds_read_b64 v[48:49], v20 offset:8192
  v_mfma_f32_16x16x32_bf16 v[104:107], v[188:191], v[152:155], v[104:107]
  ds_read_b64 v[50:51], v20 offset:16384
  s_waitcnt lgkmcnt(13)
  v_mfma_f32_16x16x32_bf16 v[108:111], v[188:191], v[156:159], v[108:111]
  ds_read_b64 v[52:53], v20 offset:24576
  s_waitcnt lgkmcnt(12)
  v_mfma_f32_16x16x32_bf16 v[96:99], v[192:195], v[148:151], v[96:99]
  v_mfma_f32_16x16x32_bf16 v[100:103], v[192:195], v[152:155], v[100:103]
  v_mfma_f32_16x16x32_bf16 v[104:107], v[192:195], v[156:159], v[104:107]
  s_waitcnt lgkmcnt(5)
  v_readfirstlane_b32 s86, v56
  v_readfirstlane_b32 s87, v57
  ds_read_b64 v[204:205], v17 offset:3712
  ds_read_b64 v[206:207], v17 offset:3720
  v_mfma_f32_16x16x32_bf16 v[108:111], v[192:195], v[160:163], v[108:111]
  v_readfirstlane_b32 s84, v58
  v_readfirstlane_b32 s85, v59
  ds_read_b128 v[172:175], v18 offset:3712
  v_mfma_f32_16x16x32_bf16 v[96:99], v[196:199], v[152:155], v[96:99]
  ds_read_b64 v[176:177], v17 offset:64
  ds_read_b64 v[178:179], v17 offset:72
  v_mfma_f32_16x16x32_bf16 v[100:103], v[196:199], v[156:159], v[100:103]
  v_add_u32 v4, 0, v65
  v_cmp_eq_u32 vcc, s86, v4
  ds_read_b128 v[112:115], v18 offset:64
  v_mfma_f32_16x16x32_bf16 v[104:107], v[196:199], v[160:163], v[104:107]
  v_cmp_eq_u32 s[78:79], s87, v4
  s_or_b64 vcc, vcc, s[78:79]
  ds_read_b64 v[180:181], v17 offset:576
  ds_read_b64 v[182:183], v17 offset:584
  v_mfma_f32_16x16x32_bf16 v[108:111], v[196:199], v[164:167], v[108:111]
  v_cndmask_b32 v61, v60, v66, vcc
  v_add_u32 v4, 1, v65
  v_mfma_f32_16x16x32_bf16 v[96:99], v[200:203], v[156:159], v[96:99]
  v_cmp_eq_u32 vcc, s86, v4
  v_cmp_eq_u32 s[78:79], s87, v4
  v_mfma_f32_16x16x32_bf16 v[100:103], v[200:203], v[160:163], v[100:103]
  s_or_b64 vcc, vcc, s[78:79]
  v_cndmask_b32 v62, v60, v66, vcc
  v_mfma_f32_16x16x32_bf16 v[104:107], v[200:203], v[164:167], v[104:107]
  s_lshl_b32 s80, s59, 2
  s_waitcnt lgkmcnt(12)
  v_mfma_f32_16x16x32_bf16 v[108:111], v[200:203], v[168:171], v[108:111]
  s_waitcnt lgkmcnt(8)
  v_add_f32 v38, v38, v46
  v_add_f32 v38, v38, v48
  ds_read_b128 v[116:119], v18 offset:576
  s_waitcnt lgkmcnt(7)
  v_mfma_f32_16x16x32_bf16 v[96:99], v[204:207], v[160:163], v[96:99]
  v_add_f32 v39, v39, v50
  v_add_f32 v39, v39, v52
  ds_read_b64 v[184:185], v17 offset:1088
  ds_read_b64 v[186:187], v17 offset:1096
  v_mfma_f32_16x16x32_bf16 v[100:103], v[204:207], v[164:167], v[100:103]
  v_add_f32 v40, v40, v47
  v_add_f32 v40, v40, v49
  ds_read_b128 v[120:123], v18 offset:1088
  v_mfma_f32_16x16x32_bf16 v[104:107], v[204:207], v[168:171], v[104:107]
  v_add_f32 v41, v41, v51
  v_add_f32 v41, v41, v53
  ds_read_b64 v[188:189], v17 offset:1600
  ds_read_b64 v[190:191], v17 offset:1608
  s_waitcnt lgkmcnt(11)
  v_mfma_f32_16x16x32_bf16 v[108:111], v[204:207], v[172:175], v[108:111]
  v_cvt_pk_bf16_f32 v54, v38, v39
  buffer_store_dword v54, v61, s[12:15], s80 offen offset:0
  ds_read_b128 v[124:127], v18 offset:1600
  s_waitcnt lgkmcnt(9)
  v_mfma_f32_16x16x32_bf16 v[108:111], v[176:179], v[112:115], v[108:111]
  v_cvt_pk_bf16_f32 v55, v40, v41
  buffer_store_dword v55, v62, s[12:15], s80 offen offset:1024
  ds_read_b64 v[192:193], v17 offset:2112
  ds_read_b64 v[194:195], v17 offset:2120
  s_waitcnt lgkmcnt(9)
  v_mfma_f32_16x16x32_bf16 v[104:107], v[180:183], v[112:115], v[104:107]
  ds_write_b128 v67, v[38:41] offset:0
  ds_read_b128 v[128:131], v18 offset:2112
  s_waitcnt lgkmcnt(10)
  v_mfma_f32_16x16x32_bf16 v[108:111], v[180:183], v[116:119], v[108:111]
  s_mov_b64 exec, 1
  ds_add_u32 v8, v10 offset:12324
  s_mov_b64 exec, -1
  ds_read_b64 v[196:197], v17 offset:2624
  ds_read_b64 v[198:199], v17 offset:2632
  s_waitcnt lgkmcnt(11)
  v_mfma_f32_16x16x32_bf16 v[100:103], v[184:187], v[112:115], v[100:103]
  ds_read_b128 v[132:135], v18 offset:2624
  v_mfma_f32_16x16x32_bf16 v[104:107], v[184:187], v[116:119], v[104:107]
  s_waitcnt lgkmcnt(11)
  v_mfma_f32_16x16x32_bf16 v[108:111], v[184:187], v[120:123], v[108:111]
  ds_read_b64 v[200:201], v17 offset:3136
  ds_read_b64 v[202:203], v17 offset:3144
  s_waitcnt lgkmcnt(11)
  v_mfma_f32_16x16x32_bf16 v[96:99], v[188:191], v[112:115], v[96:99]
  ds_read_b128 v[136:139], v18 offset:3136
  v_mfma_f32_16x16x32_bf16 v[100:103], v[188:191], v[116:119], v[100:103]
  v_mfma_f32_16x16x32_bf16 v[104:107], v[188:191], v[120:123], v[104:107]
  s_waitcnt lgkmcnt(11)
  v_mfma_f32_16x16x32_bf16 v[108:111], v[188:191], v[124:127], v[108:111]
  ds_read_b64 v[204:205], v17 offset:3648
  ds_read_b64 v[206:207], v17 offset:3656
  s_waitcnt lgkmcnt(11)
  v_mfma_f32_16x16x32_bf16 v[96:99], v[192:195], v[116:119], v[96:99]
  ds_read_b128 v[140:143], v18 offset:3648
  v_mfma_f32_16x16x32_bf16 v[100:103], v[192:195], v[120:123], v[100:103]
  v_mfma_f32_16x16x32_bf16 v[104:107], v[192:195], v[124:127], v[104:107]
  s_waitcnt lgkmcnt(10)
  v_mfma_f32_16x16x32_bf16 v[108:111], v[192:195], v[128:131], v[108:111]
  ds_read_b64 v[176:177], v17 offset:0
  ds_read_b64 v[178:179], v17 offset:8
  s_waitcnt lgkmcnt(9)
  v_mfma_f32_16x16x32_bf16 v[96:99], v[196:199], v[120:123], v[96:99]
  ds_read_b128 v[144:147], v18 offset:0
  v_mfma_f32_16x16x32_bf16 v[100:103], v[196:199], v[124:127], v[100:103]
  ds_read_b64 v[180:181], v17 offset:512
  ds_read_b64 v[182:183], v17 offset:520
  v_mfma_f32_16x16x32_bf16 v[104:107], v[196:199], v[128:131], v[104:107]
  ds_read_b128 v[148:151], v18 offset:512
  s_waitcnt lgkmcnt(12)
  v_mfma_f32_16x16x32_bf16 v[108:111], v[196:199], v[132:135], v[108:111]
  s_waitcnt lgkmcnt(10)
  v_mfma_f32_16x16x32_bf16 v[96:99], v[200:203], v[124:127], v[96:99]
  ds_read_b64 v[184:185], v17 offset:1024
  ds_read_b64 v[186:187], v17 offset:1032
  v_mfma_f32_16x16x32_bf16 v[100:103], v[200:203], v[128:131], v[100:103]
  ds_read_b128 v[152:155], v18 offset:1024
  v_mfma_f32_16x16x32_bf16 v[104:107], v[200:203], v[132:135], v[104:107]
  s_waitcnt lgkmcnt(12)
  v_mfma_f32_16x16x32_bf16 v[108:111], v[200:203], v[136:139], v[108:111]
  s_waitcnt lgkmcnt(10)
  v_mfma_f32_16x16x32_bf16 v[96:99], v[204:207], v[128:131], v[96:99]
  ds_read_b64 v[188:189], v17 offset:1536
  ds_read_b64 v[190:191], v17 offset:1544
  v_mfma_f32_16x16x32_bf16 v[100:103], v[204:207], v[132:135], v[100:103]
  ds_read_b128 v[156:159], v18 offset:1536
  v_mfma_f32_16x16x32_bf16 v[104:107], v[204:207], v[136:139], v[104:107]
  s_waitcnt lgkmcnt(12)
  v_mfma_f32_16x16x32_bf16 v[108:111], v[204:207], v[140:143], v[108:111]
  s_waitcnt lgkmcnt(9)
  v_mfma_f32_16x16x32_bf16 v[108:111], v[176:179], v[144:147], v[108:111]
  ds_read_b64 v[192:193], v17 offset:2048
  ds_read_b64 v[194:195], v17 offset:2056
  s_waitcnt lgkmcnt(9)
  v_mfma_f32_16x16x32_bf16 v[104:107], v[180:183], v[144:147], v[104:107]
  ds_read_b128 v[160:163], v18 offset:2048
  s_waitcnt lgkmcnt(9)
  v_mfma_f32_16x16x32_bf16 v[108:111], v[180:183], v[148:151], v[108:111]
  ds_read_b64 v[196:197], v17 offset:2560
  ds_read_b64 v[198:199], v17 offset:2568
  s_waitcnt lgkmcnt(9)
  v_mfma_f32_16x16x32_bf16 v[100:103], v[184:187], v[144:147], v[100:103]
  ds_read_b128 v[164:167], v18 offset:2560
  v_mfma_f32_16x16x32_bf16 v[104:107], v[184:187], v[148:151], v[104:107]
  ds_read_b64 v[200:201], v17 offset:3072
  ds_read_b64 v[202:203], v17 offset:3080
  s_waitcnt lgkmcnt(11)
  v_mfma_f32_16x16x32_bf16 v[108:111], v[184:187], v[152:155], v[108:111]
  ds_read_b128 v[168:171], v18 offset:3072
  s_waitcnt lgkmcnt(10)
  v_mfma_f32_16x16x32_bf16 v[96:99], v[188:191], v[144:147], v[96:99]
  ds_read_b64 v[204:205], v17 offset:3584
  ds_read_b64 v[206:207], v17 offset:3592
  v_mfma_f32_16x16x32_bf16 v[100:103], v[188:191], v[148:151], v[100:103]
  ds_read_b128 v[172:175], v18 offset:3584
  v_mfma_f32_16x16x32_bf16 v[104:107], v[188:191], v[152:155], v[104:107]
  s_waitcnt lgkmcnt(12)
  v_mfma_f32_16x16x32_bf16 v[108:111], v[188:191], v[156:159], v[108:111]
  s_waitcnt lgkmcnt(10)
  v_mfma_f32_16x16x32_bf16 v[96:99], v[192:195], v[148:151], v[96:99]
  v_mfma_f32_16x16x32_bf16 v[100:103], v[192:195], v[152:155], v[100:103]
  v_mfma_f32_16x16x32_bf16 v[104:107], v[192:195], v[156:159], v[104:107]
  s_waitcnt lgkmcnt(9)
  v_mfma_f32_16x16x32_bf16 v[108:111], v[192:195], v[160:163], v[108:111]
  s_waitcnt lgkmcnt(7)
  v_mfma_f32_16x16x32_bf16 v[96:99], v[196:199], v[152:155], v[96:99]
  v_mfma_f32_16x16x32_bf16 v[100:103], v[196:199], v[156:159], v[100:103]
  v_mfma_f32_16x16x32_bf16 v[104:107], v[196:199], v[160:163], v[104:107]
  s_waitcnt lgkmcnt(6)
  v_mfma_f32_16x16x32_bf16 v[108:111], v[196:199], v[164:167], v[108:111]
  s_waitcnt lgkmcnt(4)
  v_mfma_f32_16x16x32_bf16 v[96:99], v[200:203], v[156:159], v[96:99]
  v_mfma_f32_16x16x32_bf16 v[100:103], v[200:203], v[160:163], v[100:103]
  v_mfma_f32_16x16x32_bf16 v[104:107], v[200:203], v[164:167], v[104:107]
  s_waitcnt lgkmcnt(3)
  v_mfma_f32_16x16x32_bf16 v[108:111], v[200:203], v[168:171], v[108:111]
  s_waitcnt lgkmcnt(1)
  v_mfma_f32_16x16x32_bf16 v[96:99], v[204:207], v[160:163], v[96:99]
  v_mfma_f32_16x16x32_bf16 v[100:103], v[204:207], v[164:167], v[100:103]
  v_mfma_f32_16x16x32_bf16 v[104:107], v[204:207], v[168:171], v[104:107]
  s_waitcnt lgkmcnt(0)
  v_mfma_f32_16x16x32_bf16 v[108:111], v[204:207], v[172:175], v[108:111]
  s_cmp_ge_u32 s58, 14
  s_cbranch_scc1 L_nocw
  s_mov_b32 s69, 0
L_spin5:
  ds_read_b32 v6, v8 offset:12368
  s_add_u32 s69, s69, 1
  s_waitcnt lgkmcnt(0)
  v_readfirstlane_b32 s68, v6
  s_cmp_ge_u32 s68, 4
  s_cbranch_scc1 L_spin5_go
  s_cmp_lt_u32 s69, 4000000
  s_cbranch_scc1 L_spin5
L_spin5_go:
L_nocw:
  ds_write_b128 v19, v[96:99] offset:4096
  ds_write_b128 v19, v[100:103] offset:5120
  ds_write_b128 v19, v[104:107] offset:6144
  ds_write_b128 v19, v[108:111] offset:7168
  s_mov_b64 exec, 1
  ds_add_u32 v8, v10 offset:12312
  s_mov_b64 exec, -1
  s_branch L_epiB
L_slowA:
  s_mov_b32 s69, 0
L_spin6:
  ds_read_b32 v6, v8 offset:12308
  s_add_u32 s69, s69, 1
  s_waitcnt lgkmcnt(0)
  v_readfirstlane_b32 s68, v6
  s_cmp_ge_u32 s68, 6
  s_cbranch_scc1 L_spin6_go
  s_cmp_lt_u32 s69, 4000000
  s_cbranch_scc1 L_spin6
L_spin6_go:
  s_branch L_backA
L_helper:
  s_setprio 3
  s_cmp_ge_u32 s56, 6
  s_cbranch_scc1 L_h67
  ds_read_b128 v[110:113], v7 offset:21504
  ds_read_b128 v[114:117], v7 offset:22528
  ds_read_b128 v[118:121], v7 offset:23552
  ds_read_b128 v[122:125], v7 offset:24576
  s_waitcnt lgkmcnt(2)
  v_max_f32 v111, v111, v113
  v_med3_f32 v111, v110, v112, v111
  v_max_f32 v110, v110, v112
  v_max_f32 v115, v115, v117
  v_med3_f32 v115, v114, v116, v115
  v_max_f32 v114, v114, v116
  s_waitcnt lgkmcnt(0)
  v_max_f32 v119, v119, v121
  v_med3_f32 v119, v118, v120, v119
  v_max_f32 v118, v118, v120
  v_max_f32 v123, v123, v125
  v_med3_f32 v123, v122, v124, v123
  v_max_f32 v122, v122, v124
  v_max_f32 v111, v111, v115
  v_med3_f32 v111, v110, v114, v111
  v_max_f32 v110, v110, v114
  v_max_f32 v119, v119, v123
  v_med3_f32 v119, v118, v122, v119
  v_max_f32 v118, v118, v122
  v_max_f32 v111, v111, v119
  v_med3_f32 v111, v110, v118, v111
  v_max_f32 v110, v110, v118
  v_mov_b32 v114, 0xff800000
  v_mov_b32 v115, 0xff800000
  s_nop 0
  v_mov_b32_dpp v114, v110 row_shr:1 row_mask:0xf bank_mask:0xf
  v_mov_b32_dpp v115, v111 row_shr:1 row_mask:0xf bank_mask:0xf
  v_max_f32 v111, v111, v115
  v_med3_f32 v111, v110, v114, v111
  v_max_f32 v110, v110, v114
  v_mov_b32 v114, 0xff800000
  v_mov_b32 v115, 0xff800000
  s_nop 0
  v_mov_b32_dpp v114, v110 row_shr:2 row_mask:0xf bank_mask:0xf
  v_mov_b32_dpp v115, v111 row_shr:2 row_mask:0xf bank_mask:0xf
  v_max_f32 v111, v111, v115
  v_med3_f32 v111, v110, v114, v111
  v_max_f32 v110, v110, v114
  v_mov_b32 v114, 0xff800000
  v_mov_b32 v115, 0xff800000
  s_nop 0
  v_mov_b32_dpp v114, v110 row_shr:4 row_mask:0xf bank_mask:0xf
  v_mov_b32_dpp v115, v111 row_shr:4 row_mask:0xf bank_mask:0xf
  v_max_f32 v111, v111, v115
  v_med3_f32 v111, v110, v114, v111
  v_max_f32 v110, v110, v114
  v_mov_b32 v114, 0xff800000
  v_mov_b32 v115, 0xff800000
  s_nop 0
  v_mov_b32_dpp v114, v110 row_shr:8 row_mask:0xf bank_mask:0xf
  v_mov_b32_dpp v115, v111 row_shr:8 row_mask:0xf bank_mask:0xf
  v_max_f32 v111, v111, v115
  v_med3_f32 v111, v110, v114, v111
  v_max_f32 v110, v110, v114
  v_mov_b32 v114, 0xff800000
  v_mov_b32 v115, 0xff800000
  s_nop 0
  v_mov_b32_dpp v114, v110 row_bcast:15 row_mask:0xa bank_mask:0xf
  v_mov_b32_dpp v115, v111 row_bcast:15 row_mask:0xa bank_mask:0xf
  v_max_f32 v111, v111, v115
  v_med3_f32 v111, v110, v114, v111
  v_max_f32 v110, v110, v114
  v_mov_b32 v114, 0xff800000
  v_mov_b32 v115, 0xff800000
  s_nop 0
  v_mov_b32_dpp v114, v110 row_bcast:31 row_mask:0xc bank_mask:0xf
  v_mov_b32_dpp v115, v111 row_bcast:31 row_mask:0xc bank_mask:0xf
  v_max_f32 v111, v111, v115
  v_med3_f32 v111, v110, v114, v111
  v_max_f32 v110, v110, v114
  s_nop 0
  v_readlane_b32 s84, v110, 63
  v_readlane_b32 s85, v111, 63
  s_and_b32 s86, s84, 0xffff
  s_sub_u32 s86, 0xffff, s86
  s_and_b32 s87, s85, 0xffff
  s_sub_u32 s87, 0xffff, s87
  s_cmp_eq_u32 s56, 4
  s_cselect_b32 s88, s86, s87
  s_lshl_b32 s68, s88, 10
  s_lshl_b32 s69, s88, 2
  s_cmp_ge_u32 s58, 14
  s_cbranch_scc1 L_norow
  buffer_load_dwordx4 v[72:75], v7, s[8:11], s68 offen
  v_mov_b32 v4, s69
  ds_read_b32 v76, v4 offset:13312
L_norow:
  s_cmp_lg_u32 s56, 4
  s_cbranch_scc1 L_notop
  v_mov_b32 v56, s86
  v_mov_b32 v57, s87
  v_mov_b32 v58, s84
  v_mov_b32 v59, s85
  s_mov_b64 exec, 1
  ds_write_b128 v8, v[56:59] offset:12336
  s_mov_b64 exec, -1
L_notop:
  s_mov_b64 exec, 1
  ds_add_u32 v8, v10 offset:12308
  s_mov_b64 exec, -1
  s_cmp_ge_u32 s58, 14
  s_cbranch_scc1 L_epiA
  v_add_u32 v3, 99328, v12
  ds_read_b32 v94, v3 offset:0
  ds_read_b32 v95, v3 offset:1024
  ds_read_b32 v96, v3 offset:2048
  ds_read_b32 v97, v3 offset:3072
  ds_read_b32 v98, v3 offset:8192
  ds_read_b32 v99, v3 offset:9216
  ds_read_b32 v100, v3 offset:10240
  ds_read_b32 v101, v3 offset:11264
  s_waitcnt lgkmcnt(4)
  ds_read_b32 v102, v3 offset:16384
  ds_read_b32 v103, v3 offset:17408
  ds_read_b32 v104, v3 offset:18432
  ds_read_b32 v105, v3 offset:19456
  ds_read_b32 v106, v3 offset:24576
  ds_read_b32 v107, v3 offset:25600
  ds_read_b32 v108, v3 offset:26624
  ds_read_b32 v109, v3 offset:27648
  s_mov_b32 s78, 0x05040100
  s_mov_b32 s79, 0x07060302
  s_waitcnt lgkmcnt(0)
  v_perm_b32 v78, v95, v94, s78
  v_perm_b32 v79, v95, v94, s79
  v_perm_b32 v80, v97, v96, s78
  v_perm_b32 v81, v97, v96, s79
  v_perm_b32 v82, v99, v98, s78
  v_perm_b32 v83, v99, v98, s79
  v_perm_b32 v84, v101, v100, s78
  v_perm_b32 v85, v101, v100, s79
  v_perm_b32 v86, v103, v102, s78
  v_perm_b32 v87, v103, v102, s79
  v_perm_b32 v88, v105, v104, s78
  v_perm_b32 v89, v105, v104, s79
  v_perm_b32 v90, v107, v106, s78
  v_perm_b32 v91, v107, v106, s79
  v_perm_b32 v92, v109, v108, s78
  v_perm_b32 v93, v109, v108, s79
  s_mov_b64 exec, 1
  ds_add_u32 v8, v10 offset:12368
  s_mov_b64 exec, -1
  s_mov_b32 s3, 1
  s_branch L_epiA0
L_ret45:
  s_waitcnt vmcnt(2)
  v_and_b32 v4, 0xffff0000, v76
  v_rcp_f32 v4, v4
  v_lshlrev_b32 v3, 16, v76
  v_lshlrev_b32 v126, 16, v72
  v_and_b32 v127, 0xffff0000, v72
  v_lshlrev_b32 v128, 16, v73
  v_and_b32 v129, 0xffff0000, v73
  v_lshlrev_b32 v130, 16, v74
  v_and_b32 v131, 0xffff0000, v74
  v_lshlrev_b32 v132, 16, v75
  v_and_b32 v133, 0xffff0000, v75
  v_mul_f32 v3, v3, v4
  v_fma_f32 v126, v126, v4, -v3
  v_fma_f32 v127, v127, v4, -v3
  v_fma_f32 v128, v128, v4, -v3
  v_fma_f32 v129, v129, v4, -v3
  v_fma_f32 v130, v130, v4, -v3
  v_fma_f32 v131, v131, v4, -v3
  v_fma_f32 v132, v132, v4, -v3
  v_fma_f32 v133, v133, v4, -v3
  v_cvt_pk_bf16_f32 v72, v126, v127
  v_cvt_pk_bf16_f32 v73, v128, v129
  v_cvt_pk_bf16_f32 v74, v130, v131
  v_cvt_pk_bf16_f32 v75, v132, v133
  s_lshl_b32 s68, s101, 10
  s_add_u32 s68, s68, 160768
  v_add_u32 v3, s68, v7
  ds_write_b128 v3, v[72:75]
  s_mov_b64 exec, 1
  ds_add_u32 v8, v10 offset:12316
  s_mov_b64 exec, -1
  s_branch L_gemv
L_h67:
  s_cmp_ge_u32 s58, 14
  s_cbranch_scc1 L_epiA
  v_lshrrev_b32 v134, 1, v1
  v_mul_u32_u24 v134, 3584, v134
  v_and_b32 v6, 1, v1
  v_lshl_add_u32 v134, v6, 4, v134
  s_and_b32 s69, s56, 1
  s_mul_i32 s68, s69, 917504
  s_lshl_b32 s3, s100, 5
  s_add_u32 s68, s68, s3
  s_lshl_b32 s69, s69, 13
  s_add_u32 m0, s69, 128000
  s_mov_b32 s69, 0
L_dmag1:
  buffer_load_dwordx4 v134, s[40:43], s68 offen lds
  s_add_u32 m0, m0, 1024
  s_add_u32 s68, s68, 114688
  buffer_load_dwordx4 v134, s[40:43], s68 offen lds
  s_add_u32 m0, m0, 1024
  s_add_u32 s68, s68, 114688
  buffer_load_dwordx4 v134, s[40:43], s68 offen lds
  s_add_u32 m0, m0, 1024
  s_add_u32 s68, s68, 114688
  buffer_load_dwordx4 v134, s[40:43], s68 offen lds
  s_add_u32 m0, m0, 1024
  s_add_u32 s68, s68, 114688
  s_add_u32 s69, s69, 1
  s_cmp_lt_u32 s69, 2
  s_cbranch_scc1 L_dmag1
  v_lshrrev_b32 v134, 1, v1
  v_mul_u32_u24 v134, 3584, v134
  v_and_b32 v6, 1, v1
  v_lshl_add_u32 v134, v6, 4, v134
  s_and_b32 s69, s56, 1
  s_mul_i32 s68, s69, 917504
  s_lshl_b32 s3, s100, 5
  s_add_u32 s68, s68, s3
  s_lshl_b32 s69, s69, 13
  s_add_u32 m0, s69, 144384
  s_mov_b32 s69, 0
L_dmau1:
  buffer_load_dwordx4 v134, s[44:47], s68 offen lds
  s_add_u32 m0, m0, 1024
  s_add_u32 s68, s68, 114688
  buffer_load_dwordx4 v134, s[44:47], s68 offen lds
  s_add_u32 m0, m0, 1024
  s_add_u32 s68, s68, 114688
  buffer_load_dwordx4 v134, s[44:47], s68 offen lds
  s_add_u32 m0, m0, 1024
  s_add_u32 s68, s68, 114688
  buffer_load_dwordx4 v134, s[44:47], s68 offen lds
  s_add_u32 m0, m0, 1024
  s_add_u32 s68, s68, 114688
  s_add_u32 s69, s69, 1
  s_cmp_lt_u32 s69, 2
  s_cbranch_scc1 L_dmau1
  v_add_u32 v3, 99328, v12
  ds_read_b32 v94, v3 offset:0
  ds_read_b32 v95, v3 offset:1024
  ds_read_b32 v96, v3 offset:2048
  ds_read_b32 v97, v3 offset:3072
  ds_read_b32 v98, v3 offset:8192
  ds_read_b32 v99, v3 offset:9216
  ds_read_b32 v100, v3 offset:10240
  ds_read_b32 v101, v3 offset:11264
  s_waitcnt lgkmcnt(4)
  ds_read_b32 v102, v3 offset:16384
  ds_read_b32 v103, v3 offset:17408
  ds_read_b32 v104, v3 offset:18432
  ds_read_b32 v105, v3 offset:19456
  ds_read_b32 v106, v3 offset:24576
  ds_read_b32 v107, v3 offset:25600
  ds_read_b32 v108, v3 offset:26624
  ds_read_b32 v109, v3 offset:27648
  s_mov_b32 s78, 0x05040100
  s_mov_b32 s79, 0x07060302
  s_waitcnt lgkmcnt(0)
  v_perm_b32 v78, v95, v94, s78
  v_perm_b32 v79, v95, v94, s79
  v_perm_b32 v80, v97, v96, s78
  v_perm_b32 v81, v97, v96, s79
  v_perm_b32 v82, v99, v98, s78
  v_perm_b32 v83, v99, v98, s79
  v_perm_b32 v84, v101, v100, s78
  v_perm_b32 v85, v101, v100, s79
  v_perm_b32 v86, v103, v102, s78
  v_perm_b32 v87, v103, v102, s79
  v_perm_b32 v88, v105, v104, s78
  v_perm_b32 v89, v105, v104, s79
  v_perm_b32 v90, v107, v106, s78
  v_perm_b32 v91, v107, v106, s79
  v_perm_b32 v92, v109, v108, s78
  v_perm_b32 v93, v109, v108, s79
  s_mov_b64 exec, 1
  ds_add_u32 v8, v10 offset:12368
  s_mov_b64 exec, -1
  s_mov_b32 s3, 2
  s_branch L_epiA0
L_ret67:
  s_waitcnt vmcnt(2)
  s_mov_b64 exec, 1
  ds_add_u32 v8, v10 offset:12316
  s_mov_b64 exec, -1
L_gemv:
  v_and_b32 v3, 1, v15
  v_lshlrev_b32 v3, 10, v3
  v_lshl_add_u32 v3, v16, 3, v3
  s_lshl_b32 s69, s101, 8
  s_add_u32 s69, s69, 160768
  v_add_u32 v134, s69, v3
  s_lshl_b32 s69, s101, 12
  s_add_u32 s69, s69, 128000
  v_lshl_add_u32 v135, v1, 3, s69
  s_mov_b32 s69, 0
L_spin7:
  ds_read_b32 v6, v8 offset:12316
  s_add_u32 s69, s69, 1
  s_waitcnt lgkmcnt(0)
  v_readfirstlane_b32 s68, v6
  s_cmp_ge_u32 s68, 4
  s_cbranch_scc1 L_spin7_go
  s_cmp_lt_u32 s69, 4000000
  s_cbranch_scc1 L_spin7
L_spin7_go:
  ds_read_b64_tr_b16 v[136:137], v135 offset:0
  ds_read_b64_tr_b16 v[138:139], v135 offset:512
  ds_read_b64_tr_b16 v[140:141], v135 offset:1024
  ds_read_b64_tr_b16 v[142:143], v135 offset:1536
  ds_read_b64_tr_b16 v[144:145], v135 offset:2048
  ds_read_b64_tr_b16 v[146:147], v135 offset:2560
  ds_read_b64_tr_b16 v[148:149], v135 offset:3072
  ds_read_b64_tr_b16 v[150:151], v135 offset:3584
  s_waitcnt lgkmcnt(4)
  ds_read_b64_tr_b16 v[152:153], v135 offset:16384
  ds_read_b64_tr_b16 v[154:155], v135 offset:16896
  ds_read_b64_tr_b16 v[156:157], v135 offset:17408
  ds_read_b64_tr_b16 v[158:159], v135 offset:17920
  ds_read_b64_tr_b16 v[160:161], v135 offset:18432
  ds_read_b64_tr_b16 v[162:163], v135 offset:18944
  ds_read_b64_tr_b16 v[164:165], v135 offset:19456
  ds_read_b64_tr_b16 v[166:167], v135 offset:19968
  s_waitcnt lgkmcnt(6)
  ds_read_b64 v[168:169], v134 offset:0
  ds_read_b64 v[170:171], v134 offset:32
  ds_read_b64 v[172:173], v134 offset:64
  ds_read_b64 v[174:175], v134 offset:96
  ds_read_b64 v[176:177], v134 offset:128
  ds_read_b64 v[178:179], v134 offset:160
  ds_read_b64 v[180:181], v134 offset:192
  ds_read_b64 v[182:183], v134 offset:224
  s_waitcnt lgkmcnt(6)
  v_mfma_f32_16x16x32_bf16 v[184:187], v[168:171], v[136:139], 0
  v_mfma_f32_16x16x32_bf16 v[188:191], v[168:171], v[152:155], 0
  s_waitcnt lgkmcnt(4)
  v_mfma_f32_16x16x32_bf16 v[184:187], v[172:175], v[140:143], v[184:187]
  v_mfma_f32_16x16x32_bf16 v[188:191], v[172:175], v[156:159], v[188:191]
  s_waitcnt lgkmcnt(2)
  v_mfma_f32_16x16x32_bf16 v[184:187], v[176:179], v[144:147], v[184:187]
  v_mfma_f32_16x16x32_bf16 v[188:191], v[176:179], v[160:163], v[188:191]
  s_waitcnt lgkmcnt(0)
  v_mfma_f32_16x16x32_bf16 v[184:187], v[180:183], v[148:151], v[184:187]
  v_mfma_f32_16x16x32_bf16 v[188:191], v[180:183], v[164:167], v[188:191]
  s_lshl_b32 s69, s101, 8
  s_add_u32 s69, s69, 162816
  v_lshl_add_u32 v5, v1, 2, s69
  v_mov_b32 v192, 0
  v_mov_b32 v193, 0
  v_mov_b32 v194, 0
  v_mov_b32 v196, 0
  v_mov_b32 v197, 0
  v_mov_b32 v198, 0
  v_mov_b32 v195, s60
  v_mov_b32 v199, s60
  v_cmp_eq_u32 vcc, 0, v16
  s_nop 1
  v_cndmask_b32 v3, v185, v184, vcc
  v_cmp_eq_u32 vcc, 2, v16
  s_nop 1
  v_cndmask_b32 v4, v189, v188, vcc
  v_cmp_gt_u32 vcc, 2, v16
  s_nop 1
  v_cndmask_b32 v3, v4, v3, vcc
  ds_write_b32 v5, v3
  s_mov_b64 exec, 1
  ds_add_u32 v8, v10 offset:12320
  s_mov_b64 exec, -1
  v_lshlrev_b32 v4, 2, v1
  v_add_u32 v4, 162816, v4
  s_mov_b32 s69, 0
L_spin8:
  ds_read_b32 v6, v8 offset:12320
  s_add_u32 s69, s69, 1
  s_waitcnt lgkmcnt(0)
  v_readfirstlane_b32 s68, v6
  s_cmp_ge_u32 s68, 4
  s_cbranch_scc1 L_spin8_go
  s_cmp_lt_u32 s69, 4000000
  s_cbranch_scc1 L_spin8
L_spin8_go:
  ds_read_b32 v200, v4 offset:0
  ds_read_b32 v201, v4 offset:256
  ds_read_b32 v202, v4 offset:512
  ds_read_b32 v203, v4 offset:768
  s_waitcnt lgkmcnt(0)
  v_add_f32 v200, v200, v201
  v_add_f32 v202, v202, v203
  v_add_f32 v200, v200, v202
  v_cvt_pk_bf16_f32 v200, v200, v200
  v_and_b32 v200, 0xffff0000, v200
  v_mov_b32 v201, v200
  s_nop 1
  v_permlane32_swap_b32 v200, v201
  v_mul_f32 v3, 0xbfb8aa3b, v200
  v_exp_f32 v3, v3
  s_nop 0
  v_add_f32 v3, 1.0, v3
  v_rcp_f32 v3, v3
  s_nop 0
  v_mul_f32 v3, v3, v200
  v_cvt_pk_bf16_f32 v3, v3, v3
  v_and_b32 v3, 0xffff0000, v3
  v_mul_f32 v3, v3, v201
  v_cvt_pk_bf16_f32 v3, v3, v3
  v_and_b32 v3, 0xffff, v3
  s_nop 1
  v_mov_b32_dpp v4, v3 quad_perm:[1,0,3,2] row_mask:0xf bank_mask:0xf bound_ctrl:0
  v_lshl_or_b32 v3, v4, 16, v3
  s_nop 0
  v_readlane_b32 s80, v3, 0
  v_readlane_b32 s81, v3, 16
  v_readlane_b32 s82, v3, 2
  v_readlane_b32 s83, v3, 18
  v_readlane_b32 s84, v3, 4
  v_readlane_b32 s85, v3, 20
  v_readlane_b32 s86, v3, 6
  v_readlane_b32 s87, v3, 22
  v_readlane_b32 s88, v3, 8
  v_readlane_b32 s89, v3, 24
  v_readlane_b32 s90, v3, 10
  v_readlane_b32 s91, v3, 26
  v_readlane_b32 s92, v3, 12
  v_readlane_b32 s93, v3, 28
  v_readlane_b32 s94, v3, 14
  v_readlane_b32 s95, v3, 30
  v_dot2_f32_bf16 v192, s80, v78, v192
  v_dot2_f32_bf16 v193, s80, v79, v193
  v_dot2_f32_bf16 v194, s81, v78, v194
  v_dot2_f32_bf16 v196, s81, v79, v196
  v_dot2_f32_bf16 v192, s82, v80, v192
  v_dot2_f32_bf16 v193, s82, v81, v193
  v_dot2_f32_bf16 v194, s83, v80, v194
  v_dot2_f32_bf16 v196, s83, v81, v196
  v_dot2_f32_bf16 v192, s84, v82, v192
  v_dot2_f32_bf16 v193, s84, v83, v193
  v_dot2_f32_bf16 v194, s85, v82, v194
  v_dot2_f32_bf16 v196, s85, v83, v196
  v_dot2_f32_bf16 v192, s86, v84, v192
  v_dot2_f32_bf16 v193, s86, v85, v193
  v_dot2_f32_bf16 v194, s87, v84, v194
  v_dot2_f32_bf16 v196, s87, v85, v196
  v_dot2_f32_bf16 v192, s88, v86, v192
  v_dot2_f32_bf16 v193, s88, v87, v193
  v_dot2_f32_bf16 v194, s89, v86, v194
  v_dot2_f32_bf16 v196, s89, v87, v196
  v_dot2_f32_bf16 v192, s90, v88, v192
  v_dot2_f32_bf16 v193, s90, v89, v193
  v_dot2_f32_bf16 v194, s91, v88, v194
  v_dot2_f32_bf16 v196, s91, v89, v196
  v_dot2_f32_bf16 v192, s92, v90, v192
  v_dot2_f32_bf16 v193, s92, v91, v193
  v_dot2_f32_bf16 v194, s93, v90, v194
  v_dot2_f32_bf16 v196, s93, v91, v196
  v_dot2_f32_bf16 v192, s94, v92, v192
  v_dot2_f32_bf16 v193, s94, v93, v193
  v_dot2_f32_bf16 v194, s95, v92, v194
  v_dot2_f32_bf16 v196, s95, v93, v196
  v_lshlrev_b32 v4, 3, v12
  s_lshl_b32 s68, s100, 13
  s_add_u32 s68, s68, 4259840
  s_nop 1
  buffer_store_dwordx4 v[192:195], v4, s[16:19], s68 offen sc1
  buffer_store_dwordx4 v[196:199], v4, s[16:19], s68 offen offset:16 sc1
  s_setprio 0
  ds_read_b128 v[56:59], v8 offset:12336
  s_waitcnt lgkmcnt(0)
  v_readfirstlane_b32 s86, v56
  v_readfirstlane_b32 s87, v57
  v_readfirstlane_b32 s84, v58
  v_readfirstlane_b32 s85, v59
  s_branch L_epiB
L_epiA:
  s_setprio 0
  s_mov_b32 s3, 0
L_epiA0:
  v_lshlrev_b32 v63, 16, v68
  v_and_b32 v64, 0xffff0000, v68
  v_add_f32 v63, 1.0, v63
  v_add_f32 v64, 1.0, v64
  v_fma_f32 v38, v30, v63, v22
  v_fma_f32 v39, v31, v64, v23
  v_fma_f32 v40, v32, v63, v24
  v_fma_f32 v41, v33, v64, v25
  v_fma_f32 v42, v34, v63, v26
  v_fma_f32 v43, v35, v64, v27
  v_fma_f32 v44, v36, v63, v28
  v_fma_f32 v45, v37, v64, v29
  v_lshlrev_b32 v60, 11, v0
  v_lshlrev_b32 v65, 1, v0
  v_mov_b32 v66, 0x7ff00000
  v_add_u32 v67, 58880, v11
  s_mov_b32 s69, 0
L_spin9:
  ds_read_b32 v6, v8 offset:12308
  s_add_u32 s69, s69, 1
  s_waitcnt lgkmcnt(0)
  v_readfirstlane_b32 s68, v6
  s_cmp_ge_u32 s68, 6
  s_cbranch_scc1 L_spin9_go
  s_cmp_lt_u32 s69, 4000000
  s_cbranch_scc1 L_spin9
L_spin9_go:
  ds_read_b128 v[56:59], v8 offset:12336
  ds_read_b64 v[46:47], v20 offset:0
  ds_read_b64 v[48:49], v20 offset:8192
  ds_read_b64 v[50:51], v20 offset:16384
  ds_read_b64 v[52:53], v20 offset:24576
  s_waitcnt lgkmcnt(4)
  v_readfirstlane_b32 s86, v56
  v_readfirstlane_b32 s87, v57
  v_readfirstlane_b32 s84, v58
  v_readfirstlane_b32 s85, v59
  v_add_u32 v4, 0, v65
  v_cmp_eq_u32 vcc, s86, v4
  v_cmp_eq_u32 s[78:79], s87, v4
  s_or_b64 vcc, vcc, s[78:79]
  v_cndmask_b32 v61, v60, v66, vcc
  v_add_u32 v4, 1, v65
  v_cmp_eq_u32 vcc, s86, v4
  v_cmp_eq_u32 s[78:79], s87, v4
  s_or_b64 vcc, vcc, s[78:79]
  v_cndmask_b32 v62, v60, v66, vcc
  s_lshl_b32 s80, s59, 2
  s_waitcnt lgkmcnt(0)
  v_add_f32 v38, v38, v46
  v_add_f32 v38, v38, v48
  v_add_f32 v39, v39, v50
  v_add_f32 v39, v39, v52
  v_add_f32 v40, v40, v47
  v_add_f32 v40, v40, v49
  v_add_f32 v41, v41, v51
  v_add_f32 v41, v41, v53
  v_cvt_pk_bf16_f32 v54, v38, v39
  buffer_store_dword v54, v61, s[12:15], s80 offen offset:0
  v_cvt_pk_bf16_f32 v55, v40, v41
  buffer_store_dword v55, v62, s[12:15], s80 offen offset:1024
  ds_write_b128 v67, v[38:41] offset:0
  s_mov_b64 exec, 1
  ds_add_u32 v8, v10 offset:12324
  s_mov_b64 exec, -1
  s_cmp_eq_u32 s3, 1
  s_cbranch_scc1 L_ret45
  s_cmp_eq_u32 s3, 2
  s_cbranch_scc1 L_ret67
L_epiB:
  s_mov_b32 s69, 0
L_spin10:
  ds_read_b32 v6, v8 offset:12312
  s_add_u32 s69, s69, 1
  s_waitcnt lgkmcnt(0)
  v_readfirstlane_b32 s68, v6
  s_cmp_ge_u32 s68, 4
  s_cbranch_scc1 L_spin10_go
  s_cmp_lt_u32 s69, 4000000
  s_cbranch_scc1 L_spin10
L_spin10_go:
  ds_read_b64 v[46:47], v20 offset:4096
  ds_read_b64 v[48:49], v20 offset:12288
  ds_read_b64 v[50:51], v20 offset:20480
  ds_read_b64 v[52:53], v20 offset:28672
  v_add_u32 v4, 1024, v65
  v_cmp_eq_u32 vcc, s86, v4
  v_cmp_eq_u32 s[78:79], s87, v4
  s_or_b64 vcc, vcc, s[78:79]
  v_cndmask_b32 v61, v60, v66, vcc
  v_add_u32 v4, 1025, v65
  v_cmp_eq_u32 vcc, s86, v4
  v_cmp_eq_u32 s[78:79], s87, v4
  s_or_b64 vcc, vcc, s[78:79]
  v_cndmask_b32 v62, v60, v66, vcc
  s_lshl_b32 s80, s59, 2
  s_add_u32 s80, s80, 0x100000
  s_waitcnt lgkmcnt(0)
  v_add_f32 v42, v42, v46
  v_add_f32 v42, v42, v48
  v_add_f32 v43, v43, v50
  v_add_f32 v43, v43, v52
  v_add_f32 v44, v44, v47
  v_add_f32 v44, v44, v49
  v_add_f32 v45, v45, v51
  v_add_f32 v45, v45, v53
  v_cvt_pk_bf16_f32 v54, v42, v43
  buffer_store_dword v54, v61, s[12:15], s80 offen offset:0
  v_cvt_pk_bf16_f32 v55, v44, v45
  buffer_store_dword v55, v62, s[12:15], s80 offen offset:1024
  ds_write_b128 v67, v[42:45] offset:8192
  s_mov_b64 exec, 1
  ds_add_u32 v8, v10 offset:12324
  s_mov_b64 exec, -1
  s_cmp_lg_u32 s56, 4
  s_cbranch_scc1 L_fin
  v_lshlrev_b32 v94, 13, v1
  v_add_u32 v95, 0x80000, v94
  v_cmp_gt_u32 vcc, 48, v1
  s_nop 1
  v_cndmask_b32 v95, v66, v95, vcc
  s_mov_b64 s[90:91], vcc
  s_lshl_b32 s92, s59, 5
  s_add_u32 s92, s92, 4259840
  s_mov_b32 s93, 0
  v_mul_u32_u24 v100, 28, v1
  s_mul_i32 s94, s59, 5
  s_and_b32 s94, s94, 15
  v_add_u32 v100, s94, v100
  v_lshlrev_b32 v100, 13, v100
  s_mov_b64 exec, 15
L_rpoll:
  buffer_load_dword v101, v100, s[16:19], s92 offen offset:28 sc1
  s_waitcnt vmcnt(0)
  v_cmp_ne_u32 vcc, s60, v101
  s_cbranch_vccz L_rok
  s_add_u32 s93, s93, 1
  s_cmp_lt_u32 s93, 100000
  s_cbranch_scc1 L_rpoll
L_rok:
  s_mov_b64 exec, -1
  s_mov_b32 s93, 0
  buffer_load_dwordx4 v[78:81], v94, s[16:19], s92 offen sc1
  buffer_load_dwordx4 v[82:85], v94, s[16:19], s92 offen offset:16 sc1
  buffer_load_dwordx4 v[86:89], v95, s[16:19], s92 offen sc1
  buffer_load_dwordx4 v[90:93], v95, s[16:19], s92 offen offset:16 sc1
  v_cmp_eq_u32 vcc, 0, v1
  v_mov_b32 v4, s87
  v_mov_b32 v5, s86
  v_cndmask_b32 v4, v4, v5, vcc
  v_mov_b32 v5, s85
  v_mov_b32 v6, s84
  v_cndmask_b32 v5, v5, v6, vcc
  v_lshlrev_b32 v102, 3, v4
  s_mov_b32 s69, 0
L_spin11:
  ds_read_b32 v6, v8 offset:12324
  s_add_u32 s69, s69, 1
  s_waitcnt lgkmcnt(0)
  v_readfirstlane_b32 s68, v6
  s_cmp_ge_u32 s68, 16
  s_cbranch_scc1 L_spin11_go
  s_cmp_lt_u32 s69, 4000000
  s_cbranch_scc1 L_spin11
L_spin11_go:
  ds_read_b64 v[100:101], v102 offset:58880
  v_and_b32 v5, 0xffff0000, v5
  v_mul_f32 v5, 0xbfb8aa3b, v5
  v_exp_f32 v5, v5
  s_nop 0
  v_add_f32 v5, 1.0, v5
  v_rcp_f32 v5, v5
  s_nop 0
  v_cvt_pk_bf16_f32 v5, v5, v5
  v_and_b32 v5, 0xffff0000, v5
  v_lshlrev_b32 v4, 10, v4
L_ppoll:
  s_waitcnt vmcnt(0)
  v_cmp_ne_u32 vcc, s60, v89
  v_cmp_ne_u32 s[78:79], s60, v93
  v_cmp_ne_u32 s[80:81], s60, v81
  v_cmp_ne_u32 s[82:83], s60, v85
  s_or_b64 vcc, vcc, s[78:79]
  s_and_b64 vcc, vcc, s[90:91]
  s_or_b64 s[80:81], s[80:81], s[82:83]
  s_or_b64 vcc, vcc, s[80:81]
  s_cbranch_vccz L_pok
  s_add_u32 s93, s93, 1
  s_cmp_ge_u32 s93, 100000
  s_cbranch_scc1 L_pok
  buffer_load_dwordx4 v[78:81], v94, s[16:19], s92 offen sc1
  buffer_load_dwordx4 v[82:85], v94, s[16:19], s92 offen offset:16 sc1
  buffer_load_dwordx4 v[86:89], v95, s[16:19], s92 offen sc1
  buffer_load_dwordx4 v[90:93], v95, s[16:19], s92 offen offset:16 sc1
  s_branch L_ppoll
L_pok:
  v_add_f32 v96, v78, v86
  v_add_f32 v97, v79, v87
  v_add_f32 v98, v80, v88
  v_add_f32 v99, v82, v90
  v_add_f32_dpp v96, v96, v96 row_shr:1 row_mask:0xf bank_mask:0xf bound_ctrl:0
  v_add_f32_dpp v97, v97, v97 row_shr:1 row_mask:0xf bank_mask:0xf bound_ctrl:0
  v_add_f32_dpp v98, v98, v98 row_shr:1 row_mask:0xf bank_mask:0xf bound_ctrl:0
  v_add_f32_dpp v99, v99, v99 row_shr:1 row_mask:0xf bank_mask:0xf bound_ctrl:0
  v_add_f32_dpp v96, v96, v96 row_shr:2 row_mask:0xf bank_mask:0xf bound_ctrl:0
  v_add_f32_dpp v97, v97, v97 row_shr:2 row_mask:0xf bank_mask:0xf bound_ctrl:0
  v_add_f32_dpp v98, v98, v98 row_shr:2 row_mask:0xf bank_mask:0xf bound_ctrl:0
  v_add_f32_dpp v99, v99, v99 row_shr:2 row_mask:0xf bank_mask:0xf bound_ctrl:0
  v_add_f32_dpp v96, v96, v96 row_shr:4 row_mask:0xf bank_mask:0xf bound_ctrl:0
  v_add_f32_dpp v97, v97, v97 row_shr:4 row_mask:0xf bank_mask:0xf bound_ctrl:0
  v_add_f32_dpp v98, v98, v98 row_shr:4 row_mask:0xf bank_mask:0xf bound_ctrl:0
  v_add_f32_dpp v99, v99, v99 row_shr:4 row_mask:0xf bank_mask:0xf bound_ctrl:0
  v_add_f32_dpp v96, v96, v96 row_shr:8 row_mask:0xf bank_mask:0xf bound_ctrl:0
  v_add_f32_dpp v97, v97, v97 row_shr:8 row_mask:0xf bank_mask:0xf bound_ctrl:0
  v_add_f32_dpp v98, v98, v98 row_shr:8 row_mask:0xf bank_mask:0xf bound_ctrl:0
  v_add_f32_dpp v99, v99, v99 row_shr:8 row_mask:0xf bank_mask:0xf bound_ctrl:0
  v_add_f32_dpp v96, v96, v96 row_bcast:15 row_mask:0xa bank_mask:0xf
  v_add_f32_dpp v97, v97, v97 row_bcast:15 row_mask:0xa bank_mask:0xf
  v_add_f32_dpp v98, v98, v98 row_bcast:15 row_mask:0xa bank_mask:0xf
  v_add_f32_dpp v99, v99, v99 row_bcast:15 row_mask:0xa bank_mask:0xf
  v_add_f32_dpp v96, v96, v96 row_bcast:31 row_mask:0xc bank_mask:0xf
  v_add_f32_dpp v97, v97, v97 row_bcast:31 row_mask:0xc bank_mask:0xf
  v_add_f32_dpp v98, v98, v98 row_bcast:31 row_mask:0xc bank_mask:0xf
  v_add_f32_dpp v99, v99, v99 row_bcast:31 row_mask:0xc bank_mask:0xf
  v_readlane_b32 s92, v96, 63
  v_readlane_b32 s93, v97, 63
  v_readlane_b32 s94, v98, 63
  v_readlane_b32 s95, v99, 63
  v_cmp_eq_u32 vcc, 0, v1
  v_mov_b32 v96, s94
  v_mov_b32 v97, s95
  v_mov_b32 v98, s92
  v_mov_b32 v99, s93
  v_cndmask_b32 v96, v96, v98, vcc
  v_cndmask_b32 v97, v97, v99, vcc
  v_cvt_pk_bf16_f32 v96, v96, v97
  v_and_b32 v97, 0xffff0000, v96
  v_lshlrev_b32 v96, 16, v96
  s_waitcnt lgkmcnt(0)
  v_fma_f32 v96, v96, v5, v100
  v_fma_f32 v97, v97, v5, v101
  v_cvt_pk_bf16_f32 v96, v96, v97
  s_lshl_b32 s68, s59, 2
  s_mov_b64 exec, 3
  buffer_store_dword v96, v4, s[12:15], s68 offen
  s_mov_b64 exec, -1
  s_cmp_lg_u32 s2, 0
  s_cbranch_scc1 L_fin
  s_mov_b64 exec, 1
  buffer_store_dword v8, v8, s[52:55], 0 offen sc1
  s_mov_b64 exec, -1
L_fin:
L_end:
  s_endpgm
.p2align 7
.type L_tab_idx,@object
L_tab_idx:
  .long 0x4400440,0x4400440,0x5be05be,0x5be05be,0x5be05be,0x5bc05be,0x5bc05bc,0x5bc05bc
  .long 0x5bc05bc,0x5bc05bc,0x5ba05ba,0x5ba05ba,0x5ba05ba,0x5b805ba,0x5b805b8,0x5b805b8
  .long 0x5b805b8,0x5b805b8,0x53e053e,0x53e053e,0x53e053e,0x53c053e,0x53c053c,0x53c053c
  .long 0x53c053c,0x53c053c,0x53a053a,0x53a053a,0x53a053a,0x538053a,0x5380538,0x5380538
  .long 0x5380538,0x5380538,0x4be04be,0x4be04be,0x4be04be,0x4bc04be,0x4bc04bc,0x4bc04bc
  .long 0x4bc04bc,0x4bc04bc,0x4ba04ba,0x4ba04ba,0x4ba04ba,0x4b804ba,0x4b804b8,0x4b804b8
  .long 0x4b804b8,0x4b804b8,0x43e043e,0x43e043e,0x43e043e,0x43c043e,0x43c043c,0x43c043c
  .long 0x43c043c,0x43c043c,0x43a043a,0x43a043a,0x43a043a,0x438043a,0x4380438,0x4380438
  .long 0x4380438,0x4380438,0x5b605b6,0x5b605b6,0x5b605b6,0x5b405b6,0x5b405b4,0x5b405b4
  .long 0x5b405b4,0x5b405b4,0x5b205b2,0x5b205b2,0x5b205b2,0x5b005b2,0x5b005b0,0x5b005b0
  .long 0x5b005b0,0x5b005b0,0x5360536,0x5360536,0x5360536,0x5340536,0x5340534,0x5340534
  .long 0x5340534,0x5340534,0x5320532,0x5320532,0x5320532,0x5300532,0x5300530,0x5300530
  .long 0x5300530,0x5300530,0x4b604b6,0x4b604b6,0x4b604b6,0x4b404b6,0x4b404b4,0x4b404b4
  .long 0x4b404b4,0x4b404b4,0x4b204b2,0x4b204b2,0x4b204b2,0x4b004b2,0x4b004b0,0x4b004b0
  .long 0x4b004b0,0x4b004b0,0x4360436,0x4360436,0x4360436,0x4340436,0x4340434,0x4340434
  .long 0x4340434,0x4340434,0x4320432,0x4320432,0x4320432,0x4300432,0x4300430,0x4300430
  .long 0x4300430,0x4300430,0x5ae05ae,0x5ae05ae,0x5ae05ae,0x5ac05ae,0x5ac05ac,0x5ac05ac
  .long 0x5ac05ac,0x5ac05ac,0x5aa05aa,0x5aa05aa,0x5aa05aa,0x5a805aa,0x5a805a8,0x5a805a8
  .long 0x5a805a8,0x5a805a8,0x52e052e,0x52e052e,0x52e052e,0x52c052e,0x52c052c,0x52c052c
  .long 0x52c052c,0x52c052c,0x52a052a,0x52a052a,0x52a052a,0x528052a,0x5280528,0x5280528
  .long 0x5280528,0x5280528,0x4ae04ae,0x4ae04ae,0x4ae04ae,0x4ac04ae,0x4ac04ac,0x4ac04ac
  .long 0x4ac04ac,0x4ac04ac,0x4aa04aa,0x4aa04aa,0x4aa04aa,0x4a804aa,0x4a804a8,0x4a804a8
  .long 0x4a804a8,0x4a804a8,0x42e042e,0x42e042e,0x42e042e,0x42c042e,0x42c042c,0x42c042c
  .long 0x42c042c,0x42c042c,0x42a042a,0x42a042a,0x42a042a,0x428042a,0x4280428,0x4280428
  .long 0x4280428,0x4280428,0x5a605a6,0x5a605a6,0x5a605a6,0x5a405a6,0x5a405a4,0x5a405a4
  .long 0x5a405a4,0x5a405a4,0x5a205a2,0x5a205a2,0x5a205a2,0x5a005a2,0x5a005a0,0x5a005a0
  .long 0x5a005a0,0x5a005a0,0x5260526,0x5260526,0x5260526,0x5240526,0x5240524,0x5240524
  .long 0x5240524,0x5240524,0x5220522,0x5220522,0x5220522,0x5200522,0x5200520,0x5200520
  .long 0x5200520,0x5200520,0x4a604a6,0x4a604a6,0x4a604a6,0x4a404a6,0x4a404a4,0x4a404a4
  .long 0x4a404a4,0x4a404a4,0x4a204a2,0x4a204a2,0x4a204a2,0x4a004a2,0x4a004a0,0x4a004a0
  .long 0x4a004a0,0x4a004a0,0x4260426,0x4260426,0x4260426,0x4240426,0x4240424,0x4240424
  .long 0x4240424,0x4240424,0x4220422,0x4220422,0x4220422,0x4200422,0x4200420,0x4200420
  .long 0x4200420,0x4200420,0x59e059e,0x59e059e,0x59e059e,0x59c059e,0x59c059c,0x59c059c
  .long 0x59c059c,0x59c059c,0x59a059a,0x59a059a,0x59a059a,0x598059a,0x5980598,0x5980598
  .long 0x5980598,0x5980598,0x51e051e,0x51e051e,0x51e051e,0x51c051e,0x51c051c,0x51c051c
  .long 0x51c051c,0x51c051c,0x51a051a,0x51a051a,0x51a051a,0x518051a,0x5180518,0x5180518
  .long 0x5180518,0x5180518,0x49e049e,0x49e049e,0x49e049e,0x49c049e,0x49c049c,0x49c049c
  .long 0x49c049c,0x49c049c,0x49a049a,0x49a049a,0x49a049a,0x498049a,0x4980498,0x4980498
  .long 0x4980498,0x4980498,0x41e041e,0x41e041e,0x41e041e,0x41c041e,0x41c041c,0x41c041c
  .long 0x41c041c,0x41c041c,0x41a041a,0x41a041a,0x41a041a,0x418041a,0x4180418,0x4180418
  .long 0x4180418,0x4180418,0x5960596,0x5960596,0x5960596,0x5940596,0x5940594,0x5940594
  .long 0x5940594,0x5940594,0x5920592,0x5920592,0x5920592,0x5900592,0x5900590,0x5900590
  .long 0x5900590,0x5900590,0x5160516,0x5160516,0x5160516,0x5140516,0x5140514,0x5140514
  .long 0x5140514,0x5140514,0x5120512,0x5120512,0x5120512,0x5100512,0x5100510,0x5100510
  .long 0x5100510,0x5100510,0x4960496,0x4960496,0x4960496,0x4940496,0x4940494,0x4940494
  .long 0x4940494,0x4940494,0x4920492,0x4920492,0x4920492,0x4900492,0x4900490,0x4900490
  .long 0x4900490,0x4900490,0x4160416,0x4160416,0x4160416,0x4140416,0x4140414,0x4140414
  .long 0x4140414,0x4140414,0x4120412,0x4120412,0x4120412,0x4100412,0x4100410,0x4100410
  .long 0x4100410,0x4100410,0x58e058e,0x58e058e,0x58e058e,0x58c058e,0x58c058c,0x58c058c
  .long 0x58c058c,0x58c058c,0x58a058a,0x58a058a,0x58a058a,0x588058a,0x5880588,0x5880588
  .long 0x5880588,0x5880588,0x50e050e,0x50e050e,0x50e050e,0x50c050e,0x50c050c,0x50c050c
  .long 0x50c050c,0x50c050c,0x50a050a,0x50a050a,0x50a050a,0x508050a,0x5080508,0x5080508
  .long 0x5080508,0x5080508,0x48e048e,0x48e048e,0x48e048e,0x48c048e,0x48c048c,0x48c048c
  .long 0x48c048c,0x48c048c,0x48a048a,0x48a048a,0x48a048a,0x488048a,0x4880488,0x4880488
  .long 0x4880488,0x4880488,0x40e040e,0x40e040e,0x40e040e,0x40c040e,0x40c040c,0x40c040c
  .long 0x40c040c,0x40c040c,0x40a040a,0x40a040a,0x40a040a,0x408040a,0x4080408,0x4080408
  .long 0x4080408,0x4080408,0x5860586,0x5860586,0x5860586,0x5840586,0x5840584,0x5840584
  .long 0x5840584,0x5840584,0x5820582,0x5820582,0x5820582,0x5800582,0x5800580,0x5800580
  .long 0x5800580,0x5800580,0x5060506,0x5060506,0x5060506,0x5040506,0x5040504,0x5040504
  .long 0x5040504,0x5040504,0x5020502,0x5020502,0x5020502,0x5000502,0x5000500,0x5000500
  .long 0x5000500,0x5000500,0x4860486,0x4860486,0x4860486,0x4840486,0x4840484,0x4840484
  .long 0x4840484,0x4840484,0x4820482,0x4820482,0x4820482,0x4800482,0x4800480,0x4800480
  .long 0x4800480,0x4800480,0x4060406,0x4060406,0x4060406,0x4040406,0x4040404,0x4040404
  .long 0x4040404,0x4040404,0x4020402,0x4020402,0x4020402,0x4000402,0x4000400,0x4000400
  .long 0x4000400,0x3fe03fe,0x3fc03fe,0x3fc03fc,0x3fc03fc,0x3f603f6,0x3f403f6,0x3f403f4
  .long 0x3f403f4,0x3ee03ee,0x3ec03ee,0x3ec03ec,0x3ec03ec,0x3e603e6,0x3e403e6,0x3e403e4
  .long 0x3e403e4,0x3de03de,0x3dc03de,0x3dc03dc,0x3dc03dc,0x3d603d6,0x3d403d6,0x3d403d4
  .long 0x3d403d4,0x3ce03ce,0x3cc03ce,0x3cc03cc,0x3cc03cc,0x3c603c6,0x3c403c6,0x3c403c4
  .long 0x3c403c4,0x3be03be,0x3bc03be,0x3bc03bc,0x3bc03bc,0x3b603b6,0x3b403b6,0x3b403b4
  .long 0x3b403b4,0x3ae03ae,0x3ac03ae,0x3ac03ac,0x3ac03ac,0x3a603a6,0x3a403a6,0x3a403a4
  .long 0x3a403a4,0x39e039e,0x39c039e,0x39c039c,0x39c039c,0x3960396,0x3940396,0x3940394
  .long 0x3940394,0x38e038e,0x38c038e,0x38c038c,0x38c038c,0x3860386,0x3840386,0x3840384
  .long 0x3840384,0x3fa03fa,0x3f803fa,0x3f803f8,0x3f803f8,0x3f203f2,0x3f003f2,0x3f003f0
  .long 0x3f003f0,0x3ea03ea,0x3e803ea,0x3e803e8,0x3e803e8,0x3e203e2,0x3e003e2,0x3e003e0
  .long 0x3e003e0,0x3da03da,0x3d803da,0x3d803d8,0x3d803d8,0x3d203d2,0x3d003d2,0x3d003d0
  .long 0x3d003d0,0x3ca03ca,0x3c803ca,0x3c803c8,0x3c803c8,0x3c203c2,0x3c003c2,0x3c003c0
  .long 0x3c003c0,0x3ba03ba,0x3b803ba,0x3b803b8,0x3b803b8,0x3b203b2,0x3b003b2,0x3b003b0
  .long 0x3b003b0,0x3aa03aa,0x3a803aa,0x3a803a8,0x3a803a8,0x3a203a2,0x3a003a2,0x3a003a0
  .long 0x3a003a0,0x39a039a,0x398039a,0x3980398,0x3980398,0x3920392,0x3900392,0x3900390
  .long 0x3900390,0x38a038a,0x388038a,0x3880388,0x3880388,0x3820382,0x3800382,0x3800380
  .long 0x3800380,0x37e037e,0x37c037e,0x37c037c,0x37c037c,0x3760376,0x3740376,0x3740374
  .long 0x3740374,0x36e036e,0x36c036e,0x36c036c,0x36c036c,0x3660366,0x3640366,0x3640364
  .long 0x3640364,0x35e035e,0x35c035e,0x35c035c,0x35c035c,0x3560356,0x3540356,0x3540354
  .long 0x3540354,0x34e034e,0x34c034e,0x34c034c,0x34c034c,0x3460346,0x3440346,0x3440344
  .long 0x3440344,0x33e033e,0x33c033e,0x33c033c,0x33c033c,0x3360336,0x3340336,0x3340334
  .long 0x3340334,0x32e032e,0x32c032e,0x32c032c,0x32c032c,0x3260326,0x3240326,0x3240324
  .long 0x3240324,0x31e031e,0x31c031e,0x31c031c,0x31c031c,0x3160316,0x3140316,0x3140314
  .long 0x3140314,0x30e030e,0x30c030e,0x30c030c,0x30c030c,0x3060306,0x3040306,0x3040304
  .long 0x3040304,0x37a037a,0x378037a,0x3780378,0x3780378,0x3720372,0x3700372,0x3700370
  .long 0x3700370,0x36a036a,0x368036a,0x3680368,0x3680368,0x3620362,0x3600362,0x3600360
  .long 0x3600360,0x35a035a,0x358035a,0x3580358,0x3580358,0x3520352,0x3500352,0x3500350
  .long 0x3500350,0x34a034a,0x348034a,0x3480348,0x3480348,0x3420342,0x3400342,0x3400340
  .long 0x3400340,0x33a033a,0x338033a,0x3380338,0x3380338,0x3320332,0x3300332,0x3300330
  .long 0x3300330,0x32a032a,0x328032a,0x3280328,0x3280328,0x3220322,0x3200322,0x3200320
  .long 0x3200320,0x31a031a,0x318031a,0x3180318,0x3180318,0x3120312,0x3100312,0x3100310
  .long 0x3100310,0x30a030a,0x308030a,0x3080308,0x3080308,0x3020302,0x3000302,0x3000300
  .long 0x2fe0300,0x2fc02fc,0x2fa02fc,0x2f802f8,0x2f602f8,0x2f402f4,0x2f202f4,0x2f002f0
  .long 0x2ee02f0,0x2ec02ec,0x2ea02ec,0x2e802e8,0x2e602e8,0x2e402e4,0x2e202e4,0x2e002e0
  .long 0x2de02e0,0x2dc02dc,0x2da02dc,0x2d802d8,0x2d602d8,0x2d402d4,0x2d202d4,0x2d002d0
  .long 0x2ce02d0,0x2cc02cc,0x2ca02cc,0x2c802c8,0x2c602c8,0x2c402c4,0x2c202c4,0x2c002c0
  .long 0x2be02c0,0x2bc02bc,0x2ba02bc,0x2b802b8,0x2b602b8,0x2b402b4,0x2b202b4,0x2b002b0
  .long 0x2ae02b0,0x2ac02ac,0x2aa02ac,0x2a802a8,0x2a602a8,0x2a402a4,0x2a202a4,0x2a002a0
  .long 0x29e02a0,0x29c029c,0x29a029c,0x2980298,0x2960298,0x2940294,0x2920294,0x2900290
  .long 0x28e0290,0x28c028c,0x28a028c,0x2880288,0x2860288,0x2840284,0x2820284,0x2800280
  .long 0x27e0280,0x27c027c,0x27a027c,0x2780278,0x2760278,0x2740274,0x2720274,0x2700270
  .long 0x26e0270,0x26c026c,0x26a026c,0x2680268,0x2660268,0x2640264,0x2620264,0x2600260
  .long 0x25e0260,0x25c025c,0x25a025c,0x2580258,0x2560258,0x2540254,0x2520254,0x2500250
  .long 0x24e0250,0x24c024c,0x24a024c,0x2480248,0x2460248,0x2440244,0x2420244,0x2400240
  .long 0x23e0240,0x23c023c,0x23a023c,0x2380238,0x2360238,0x2340234,0x2320234,0x2300230
  .long 0x22e0230,0x22c022c,0x22a022c,0x2280228,0x2260228,0x2240224,0x2220224,0x2200220
  .long 0x21e0220,0x21c021c,0x21a021c,0x2180218,0x2160218,0x2140214,0x2120214,0x2100210
  .long 0x20e0210,0x20c020c,0x20a020c,0x2080208,0x2060208,0x2040204,0x2020204,0x2000200
  .long 0x1fc01fe,0x1f801fa,0x17c017e,0x178017a,0x1f401f6,0x1f001f2,0x1740176,0x1700172
  .long 0x1ec01ee,0x1e801ea,0x16c016e,0x168016a,0x1e401e6,0x1e001e2,0x1640166,0x1600162
  .long 0x1dc01de,0x1d801da,0x15c015e,0x158015a,0x1d401d6,0x1d001d2,0x1540156,0x1500152
  .long 0x1cc01ce,0x1c801ca,0x14c014e,0x148014a,0x1c401c6,0x1c001c2,0x1440146,0x1400142
  .long 0x1bc01be,0x1b801ba,0x13c013e,0x138013a,0x1b401b6,0x1b001b2,0x1340136,0x1300132
  .long 0x1ac01ae,0x1a801aa,0x12c012e,0x128012a,0x1a401a6,0x1a001a2,0x1240126,0x1200122
  .long 0x19c019e,0x198019a,0x11c011e,0x118011a,0x1940196,0x1900192,0x1140116,0x1100112
  .long 0x18c018e,0x188018a,0x10c010e,0x108010a,0x1840186,0x1800182,0x1040106,0x1000102
  .long 0xfc00fe,0xf800fa,0x7c007e,0x78007a,0xf400f6,0xf000f2,0x740076,0x700072
  .long 0xec00ee,0xe800ea,0x6c006e,0x68006a,0xe400e6,0xe000e2,0x640066,0x600062
  .long 0xdc00de,0xd800da,0x5c005e,0x58005a,0xd400d6,0xd000d2,0x540056,0x500052
  .long 0xcc00ce,0xc800ca,0x4c004e,0x48004a,0xc400c6,0xc000c2,0x440046,0x400042
  .long 0xbc00be,0xb800ba,0x3c003e,0x38003a,0xb400b6,0xb000b2,0x340036,0x300032
  .long 0xac00ae,0xa800aa,0x2c002e,0x28002a,0xa400a6,0xa000a2,0x240026,0x200022
  .long 0x9c009e,0x98009a,0x1c001e,0x18001a,0x940096,0x900092,0x140016,0x100012
  .long 0x8c008e,0x88008a,0xc000e,0x8000a,0x840086,0x800082,0x40006,0x2
  .long 0x6000600,0x6000600,0x6000600,0x6000600,0x6000600,0x6000600,0x6000600,0x6000600
  .long 0x1c401c40,0x1c401c40,0x1dbe1dbe,0x1dbe1dbe,0x1dbe1dbe,0x1dbc1dbe,0x1dbc1dbc,0x1dbc1dbc
  .long 0x1dbc1dbc,0x1dbc1dbc,0x1dba1dba,0x1dba1dba,0x1dba1dba,0x1db81dba,0x1db81db8,0x1db81db8
  .long 0x1db81db8,0x1db81db8,0x1d3e1d3e,0x1d3e1d3e,0x1d3e1d3e,0x1d3c1d3e,0x1d3c1d3c,0x1d3c1d3c
  .long 0x1d3c1d3c,0x1d3c1d3c,0x1d3a1d3a,0x1d3a1d3a,0x1d3a1d3a,0x1d381d3a,0x1d381d38,0x1d381d38
  .long 0x1d381d38,0x1d381d38,0x1cbe1cbe,0x1cbe1cbe,0x1cbe1cbe,0x1cbc1cbe,0x1cbc1cbc,0x1cbc1cbc
  .long 0x1cbc1cbc,0x1cbc1cbc,0x1cba1cba,0x1cba1cba,0x1cba1cba,0x1cb81cba,0x1cb81cb8,0x1cb81cb8
  .long 0x1cb81cb8,0x1cb81cb8,0x1c3e1c3e,0x1c3e1c3e,0x1c3e1c3e,0x1c3c1c3e,0x1c3c1c3c,0x1c3c1c3c
  .long 0x1c3c1c3c,0x1c3c1c3c,0x1c3a1c3a,0x1c3a1c3a,0x1c3a1c3a,0x1c381c3a,0x1c381c38,0x1c381c38
  .long 0x1c381c38,0x1c381c38,0x1db61db6,0x1db61db6,0x1db61db6,0x1db41db6,0x1db41db4,0x1db41db4
  .long 0x1db41db4,0x1db41db4,0x1db21db2,0x1db21db2,0x1db21db2,0x1db01db2,0x1db01db0,0x1db01db0
  .long 0x1db01db0,0x1db01db0,0x1d361d36,0x1d361d36,0x1d361d36,0x1d341d36,0x1d341d34,0x1d341d34
  .long 0x1d341d34,0x1d341d34,0x1d321d32,0x1d321d32,0x1d321d32,0x1d301d32,0x1d301d30,0x1d301d30
  .long 0x1d301d30,0x1d301d30,0x1cb61cb6,0x1cb61cb6,0x1cb61cb6,0x1cb41cb6,0x1cb41cb4,0x1cb41cb4
  .long 0x1cb41cb4,0x1cb41cb4,0x1cb21cb2,0x1cb21cb2,0x1cb21cb2,0x1cb01cb2,0x1cb01cb0,0x1cb01cb0
  .long 0x1cb01cb0,0x1cb01cb0,0x1c361c36,0x1c361c36,0x1c361c36,0x1c341c36,0x1c341c34,0x1c341c34
  .long 0x1c341c34,0x1c341c34,0x1c321c32,0x1c321c32,0x1c321c32,0x1c301c32,0x1c301c30,0x1c301c30
  .long 0x1c301c30,0x1c301c30,0x1dae1dae,0x1dae1dae,0x1dae1dae,0x1dac1dae,0x1dac1dac,0x1dac1dac
  .long 0x1dac1dac,0x1dac1dac,0x1daa1daa,0x1daa1daa,0x1daa1daa,0x1da81daa,0x1da81da8,0x1da81da8
  .long 0x1da81da8,0x1da81da8,0x1d2e1d2e,0x1d2e1d2e,0x1d2e1d2e,0x1d2c1d2e,0x1d2c1d2c,0x1d2c1d2c
  .long 0x1d2c1d2c,0x1d2c1d2c,0x1d2a1d2a,0x1d2a1d2a,0x1d2a1d2a,0x1d281d2a,0x1d281d28,0x1d281d28
  .long 0x1d281d28,0x1d281d28,0x1cae1cae,0x1cae1cae,0x1cae1cae,0x1cac1cae,0x1cac1cac,0x1cac1cac
  .long 0x1cac1cac,0x1cac1cac,0x1caa1caa,0x1caa1caa,0x1caa1caa,0x1ca81caa,0x1ca81ca8,0x1ca81ca8
  .long 0x1ca81ca8,0x1ca81ca8,0x1c2e1c2e,0x1c2e1c2e,0x1c2e1c2e,0x1c2c1c2e,0x1c2c1c2c,0x1c2c1c2c
  .long 0x1c2c1c2c,0x1c2c1c2c,0x1c2a1c2a,0x1c2a1c2a,0x1c2a1c2a,0x1c281c2a,0x1c281c28,0x1c281c28
  .long 0x1c281c28,0x1c281c28,0x1da61da6,0x1da61da6,0x1da61da6,0x1da41da6,0x1da41da4,0x1da41da4
  .long 0x1da41da4,0x1da41da4,0x1da21da2,0x1da21da2,0x1da21da2,0x1da01da2,0x1da01da0,0x1da01da0
  .long 0x1da01da0,0x1da01da0,0x1d261d26,0x1d261d26,0x1d261d26,0x1d241d26,0x1d241d24,0x1d241d24
  .long 0x1d241d24,0x1d241d24,0x1d221d22,0x1d221d22,0x1d221d22,0x1d201d22,0x1d201d20,0x1d201d20
  .long 0x1d201d20,0x1d201d20,0x1ca61ca6,0x1ca61ca6,0x1ca61ca6,0x1ca41ca6,0x1ca41ca4,0x1ca41ca4
  .long 0x1ca41ca4,0x1ca41ca4,0x1ca21ca2,0x1ca21ca2,0x1ca21ca2,0x1ca01ca2,0x1ca01ca0,0x1ca01ca0
  .long 0x1ca01ca0,0x1ca01ca0,0x1c261c26,0x1c261c26,0x1c261c26,0x1c241c26,0x1c241c24,0x1c241c24
  .long 0x1c241c24,0x1c241c24,0x1c221c22,0x1c221c22,0x1c221c22,0x1c201c22,0x1c201c20,0x1c201c20
  .long 0x1c201c20,0x1c201c20,0x1d9e1d9e,0x1d9e1d9e,0x1d9e1d9e,0x1d9c1d9e,0x1d9c1d9c,0x1d9c1d9c
  .long 0x1d9c1d9c,0x1d9c1d9c,0x1d9a1d9a,0x1d9a1d9a,0x1d9a1d9a,0x1d981d9a,0x1d981d98,0x1d981d98
  .long 0x1d981d98,0x1d981d98,0x1d1e1d1e,0x1d1e1d1e,0x1d1e1d1e,0x1d1c1d1e,0x1d1c1d1c,0x1d1c1d1c
  .long 0x1d1c1d1c,0x1d1c1d1c,0x1d1a1d1a,0x1d1a1d1a,0x1d1a1d1a,0x1d181d1a,0x1d181d18,0x1d181d18
  .long 0x1d181d18,0x1d181d18,0x1c9e1c9e,0x1c9e1c9e,0x1c9e1c9e,0x1c9c1c9e,0x1c9c1c9c,0x1c9c1c9c
  .long 0x1c9c1c9c,0x1c9c1c9c,0x1c9a1c9a,0x1c9a1c9a,0x1c9a1c9a,0x1c981c9a,0x1c981c98,0x1c981c98
  .long 0x1c981c98,0x1c981c98,0x1c1e1c1e,0x1c1e1c1e,0x1c1e1c1e,0x1c1c1c1e,0x1c1c1c1c,0x1c1c1c1c
  .long 0x1c1c1c1c,0x1c1c1c1c,0x1c1a1c1a,0x1c1a1c1a,0x1c1a1c1a,0x1c181c1a,0x1c181c18,0x1c181c18
  .long 0x1c181c18,0x1c181c18,0x1d961d96,0x1d961d96,0x1d961d96,0x1d941d96,0x1d941d94,0x1d941d94
  .long 0x1d941d94,0x1d941d94,0x1d921d92,0x1d921d92,0x1d921d92,0x1d901d92,0x1d901d90,0x1d901d90
  .long 0x1d901d90,0x1d901d90,0x1d161d16,0x1d161d16,0x1d161d16,0x1d141d16,0x1d141d14,0x1d141d14
  .long 0x1d141d14,0x1d141d14,0x1d121d12,0x1d121d12,0x1d121d12,0x1d101d12,0x1d101d10,0x1d101d10
  .long 0x1d101d10,0x1d101d10,0x1c961c96,0x1c961c96,0x1c961c96,0x1c941c96,0x1c941c94,0x1c941c94
  .long 0x1c941c94,0x1c941c94,0x1c921c92,0x1c921c92,0x1c921c92,0x1c901c92,0x1c901c90,0x1c901c90
  .long 0x1c901c90,0x1c901c90,0x1c161c16,0x1c161c16,0x1c161c16,0x1c141c16,0x1c141c14,0x1c141c14
  .long 0x1c141c14,0x1c141c14,0x1c121c12,0x1c121c12,0x1c121c12,0x1c101c12,0x1c101c10,0x1c101c10
  .long 0x1c101c10,0x1c101c10,0x1d8e1d8e,0x1d8e1d8e,0x1d8e1d8e,0x1d8c1d8e,0x1d8c1d8c,0x1d8c1d8c
  .long 0x1d8c1d8c,0x1d8c1d8c,0x1d8a1d8a,0x1d8a1d8a,0x1d8a1d8a,0x1d881d8a,0x1d881d88,0x1d881d88
  .long 0x1d881d88,0x1d881d88,0x1d0e1d0e,0x1d0e1d0e,0x1d0e1d0e,0x1d0c1d0e,0x1d0c1d0c,0x1d0c1d0c
  .long 0x1d0c1d0c,0x1d0c1d0c,0x1d0a1d0a,0x1d0a1d0a,0x1d0a1d0a,0x1d081d0a,0x1d081d08,0x1d081d08
  .long 0x1d081d08,0x1d081d08,0x1c8e1c8e,0x1c8e1c8e,0x1c8e1c8e,0x1c8c1c8e,0x1c8c1c8c,0x1c8c1c8c
  .long 0x1c8c1c8c,0x1c8c1c8c,0x1c8a1c8a,0x1c8a1c8a,0x1c8a1c8a,0x1c881c8a,0x1c881c88,0x1c881c88
  .long 0x1c881c88,0x1c881c88,0x1c0e1c0e,0x1c0e1c0e,0x1c0e1c0e,0x1c0c1c0e,0x1c0c1c0c,0x1c0c1c0c
  .long 0x1c0c1c0c,0x1c0c1c0c,0x1c0a1c0a,0x1c0a1c0a,0x1c0a1c0a,0x1c081c0a,0x1c081c08,0x1c081c08
  .long 0x1c081c08,0x1c081c08,0x1d861d86,0x1d861d86,0x1d861d86,0x1d841d86,0x1d841d84,0x1d841d84
  .long 0x1d841d84,0x1d841d84,0x1d821d82,0x1d821d82,0x1d821d82,0x1d801d82,0x1d801d80,0x1d801d80
  .long 0x1d801d80,0x1d801d80,0x1d061d06,0x1d061d06,0x1d061d06,0x1d041d06,0x1d041d04,0x1d041d04
  .long 0x1d041d04,0x1d041d04,0x1d021d02,0x1d021d02,0x1d021d02,0x1d001d02,0x1d001d00,0x1d001d00
  .long 0x1d001d00,0x1d001d00,0x1c861c86,0x1c861c86,0x1c861c86,0x1c841c86,0x1c841c84,0x1c841c84
  .long 0x1c841c84,0x1c841c84,0x1c821c82,0x1c821c82,0x1c821c82,0x1c801c82,0x1c801c80,0x1c801c80
  .long 0x1c801c80,0x1c801c80,0x1c061c06,0x1c061c06,0x1c061c06,0x1c041c06,0x1c041c04,0x1c041c04
  .long 0x1c041c04,0x1c041c04,0x1c021c02,0x1c021c02,0x1c021c02,0x1c001c02,0x1c001c00,0x1c001c00
  .long 0x1c001c00,0x1bfe1bfe,0x1bfc1bfe,0x1bfc1bfc,0x1bfc1bfc,0x1bf61bf6,0x1bf41bf6,0x1bf41bf4
  .long 0x1bf41bf4,0x1bee1bee,0x1bec1bee,0x1bec1bec,0x1bec1bec,0x1be61be6,0x1be41be6,0x1be41be4
  .long 0x1be41be4,0x1bde1bde,0x1bdc1bde,0x1bdc1bdc,0x1bdc1bdc,0x1bd61bd6,0x1bd41bd6,0x1bd41bd4
  .long 0x1bd41bd4,0x1bce1bce,0x1bcc1bce,0x1bcc1bcc,0x1bcc1bcc,0x1bc61bc6,0x1bc41bc6,0x1bc41bc4
  .long 0x1bc41bc4,0x1bbe1bbe,0x1bbc1bbe,0x1bbc1bbc,0x1bbc1bbc,0x1bb61bb6,0x1bb41bb6,0x1bb41bb4
  .long 0x1bb41bb4,0x1bae1bae,0x1bac1bae,0x1bac1bac,0x1bac1bac,0x1ba61ba6,0x1ba41ba6,0x1ba41ba4
  .long 0x1ba41ba4,0x1b9e1b9e,0x1b9c1b9e,0x1b9c1b9c,0x1b9c1b9c,0x1b961b96,0x1b941b96,0x1b941b94
  .long 0x1b941b94,0x1b8e1b8e,0x1b8c1b8e,0x1b8c1b8c,0x1b8c1b8c,0x1b861b86,0x1b841b86,0x1b841b84
  .long 0x1b841b84,0x1bfa1bfa,0x1bf81bfa,0x1bf81bf8,0x1bf81bf8,0x1bf21bf2,0x1bf01bf2,0x1bf01bf0
  .long 0x1bf01bf0,0x1bea1bea,0x1be81bea,0x1be81be8,0x1be81be8,0x1be21be2,0x1be01be2,0x1be01be0
  .long 0x1be01be0,0x1bda1bda,0x1bd81bda,0x1bd81bd8,0x1bd81bd8,0x1bd21bd2,0x1bd01bd2,0x1bd01bd0
  .long 0x1bd01bd0,0x1bca1bca,0x1bc81bca,0x1bc81bc8,0x1bc81bc8,0x1bc21bc2,0x1bc01bc2,0x1bc01bc0
  .long 0x1bc01bc0,0x1bba1bba,0x1bb81bba,0x1bb81bb8,0x1bb81bb8,0x1bb21bb2,0x1bb01bb2,0x1bb01bb0
  .long 0x1bb01bb0,0x1baa1baa,0x1ba81baa,0x1ba81ba8,0x1ba81ba8,0x1ba21ba2,0x1ba01ba2,0x1ba01ba0
  .long 0x1ba01ba0,0x1b9a1b9a,0x1b981b9a,0x1b981b98,0x1b981b98,0x1b921b92,0x1b901b92,0x1b901b90
  .long 0x1b901b90,0x1b8a1b8a,0x1b881b8a,0x1b881b88,0x1b881b88,0x1b821b82,0x1b801b82,0x1b801b80
  .long 0x1b801b80,0x1b7e1b7e,0x1b7c1b7e,0x1b7c1b7c,0x1b7c1b7c,0x1b761b76,0x1b741b76,0x1b741b74
  .long 0x1b741b74,0x1b6e1b6e,0x1b6c1b6e,0x1b6c1b6c,0x1b6c1b6c,0x1b661b66,0x1b641b66,0x1b641b64
  .long 0x1b641b64,0x1b5e1b5e,0x1b5c1b5e,0x1b5c1b5c,0x1b5c1b5c,0x1b561b56,0x1b541b56,0x1b541b54
  .long 0x1b541b54,0x1b4e1b4e,0x1b4c1b4e,0x1b4c1b4c,0x1b4c1b4c,0x1b461b46,0x1b441b46,0x1b441b44
  .long 0x1b441b44,0x1b3e1b3e,0x1b3c1b3e,0x1b3c1b3c,0x1b3c1b3c,0x1b361b36,0x1b341b36,0x1b341b34
  .long 0x1b341b34,0x1b2e1b2e,0x1b2c1b2e,0x1b2c1b2c,0x1b2c1b2c,0x1b261b26,0x1b241b26,0x1b241b24
  .long 0x1b241b24,0x1b1e1b1e,0x1b1c1b1e,0x1b1c1b1c,0x1b1c1b1c,0x1b161b16,0x1b141b16,0x1b141b14
  .long 0x1b141b14,0x1b0e1b0e,0x1b0c1b0e,0x1b0c1b0c,0x1b0c1b0c,0x1b061b06,0x1b041b06,0x1b041b04
  .long 0x1b041b04,0x1b7a1b7a,0x1b781b7a,0x1b781b78,0x1b781b78,0x1b721b72,0x1b701b72,0x1b701b70
  .long 0x1b701b70,0x1b6a1b6a,0x1b681b6a,0x1b681b68,0x1b681b68,0x1b621b62,0x1b601b62,0x1b601b60
  .long 0x1b601b60,0x1b5a1b5a,0x1b581b5a,0x1b581b58,0x1b581b58,0x1b521b52,0x1b501b52,0x1b501b50
  .long 0x1b501b50,0x1b4a1b4a,0x1b481b4a,0x1b481b48,0x1b481b48,0x1b421b42,0x1b401b42,0x1b401b40
  .long 0x1b401b40,0x1b3a1b3a,0x1b381b3a,0x1b381b38,0x1b381b38,0x1b321b32,0x1b301b32,0x1b301b30
  .long 0x1b301b30,0x1b2a1b2a,0x1b281b2a,0x1b281b28,0x1b281b28,0x1b221b22,0x1b201b22,0x1b201b20
  .long 0x1b201b20,0x1b1a1b1a,0x1b181b1a,0x1b181b18,0x1b181b18,0x1b121b12,0x1b101b12,0x1b101b10
  .long 0x1b101b10,0x1b0a1b0a,0x1b081b0a,0x1b081b08,0x1b081b08,0x1b021b02,0x1b001b02,0x1b001b00
  .long 0x1afe1b00,0x1afc1afc,0x1afa1afc,0x1af81af8,0x1af61af8,0x1af41af4,0x1af21af4,0x1af01af0
  .long 0x1aee1af0,0x1aec1aec,0x1aea1aec,0x1ae81ae8,0x1ae61ae8,0x1ae41ae4,0x1ae21ae4,0x1ae01ae0
  .long 0x1ade1ae0,0x1adc1adc,0x1ada1adc,0x1ad81ad8,0x1ad61ad8,0x1ad41ad4,0x1ad21ad4,0x1ad01ad0
  .long 0x1ace1ad0,0x1acc1acc,0x1aca1acc,0x1ac81ac8,0x1ac61ac8,0x1ac41ac4,0x1ac21ac4,0x1ac01ac0
  .long 0x1abe1ac0,0x1abc1abc,0x1aba1abc,0x1ab81ab8,0x1ab61ab8,0x1ab41ab4,0x1ab21ab4,0x1ab01ab0
  .long 0x1aae1ab0,0x1aac1aac,0x1aaa1aac,0x1aa81aa8,0x1aa61aa8,0x1aa41aa4,0x1aa21aa4,0x1aa01aa0
  .long 0x1a9e1aa0,0x1a9c1a9c,0x1a9a1a9c,0x1a981a98,0x1a961a98,0x1a941a94,0x1a921a94,0x1a901a90
  .long 0x1a8e1a90,0x1a8c1a8c,0x1a8a1a8c,0x1a881a88,0x1a861a88,0x1a841a84,0x1a821a84,0x1a801a80
  .long 0x1a7e1a80,0x1a7c1a7c,0x1a7a1a7c,0x1a781a78,0x1a761a78,0x1a741a74,0x1a721a74,0x1a701a70
  .long 0x1a6e1a70,0x1a6c1a6c,0x1a6a1a6c,0x1a681a68,0x1a661a68,0x1a641a64,0x1a621a64,0x1a601a60
  .long 0x1a5e1a60,0x1a5c1a5c,0x1a5a1a5c,0x1a581a58,0x1a561a58,0x1a541a54,0x1a521a54,0x1a501a50
  .long 0x1a4e1a50,0x1a4c1a4c,0x1a4a1a4c,0x1a481a48,0x1a461a48,0x1a441a44,0x1a421a44,0x1a401a40
  .long 0x1a3e1a40,0x1a3c1a3c,0x1a3a1a3c,0x1a381a38,0x1a361a38,0x1a341a34,0x1a321a34,0x1a301a30
  .long 0x1a2e1a30,0x1a2c1a2c,0x1a2a1a2c,0x1a281a28,0x1a261a28,0x1a241a24,0x1a221a24,0x1a201a20
  .long 0x1a1e1a20,0x1a1c1a1c,0x1a1a1a1c,0x1a181a18,0x1a161a18,0x1a141a14,0x1a121a14,0x1a101a10
  .long 0x1a0e1a10,0x1a0c1a0c,0x1a0a1a0c,0x1a081a08,0x1a061a08,0x1a041a04,0x1a021a04,0x1a001a00
  .long 0x19fc19fe,0x19f819fa,0x197c197e,0x1978197a,0x19f419f6,0x19f019f2,0x19741976,0x19701972
  .long 0x19ec19ee,0x19e819ea,0x196c196e,0x1968196a,0x19e419e6,0x19e019e2,0x19641966,0x19601962
  .long 0x19dc19de,0x19d819da,0x195c195e,0x1958195a,0x19d419d6,0x19d019d2,0x19541956,0x19501952
  .long 0x19cc19ce,0x19c819ca,0x194c194e,0x1948194a,0x19c419c6,0x19c019c2,0x19441946,0x19401942
  .long 0x19bc19be,0x19b819ba,0x193c193e,0x1938193a,0x19b419b6,0x19b019b2,0x19341936,0x19301932
  .long 0x19ac19ae,0x19a819aa,0x192c192e,0x1928192a,0x19a419a6,0x19a019a2,0x19241926,0x19201922
  .long 0x199c199e,0x1998199a,0x191c191e,0x1918191a,0x19941996,0x19901992,0x19141916,0x19101912
  .long 0x198c198e,0x1988198a,0x190c190e,0x1908190a,0x19841986,0x19801982,0x19041906,0x19001902
  .long 0x18fc18fe,0x18f818fa,0x187c187e,0x1878187a,0x18f418f6,0x18f018f2,0x18741876,0x18701872
  .long 0x18ec18ee,0x18e818ea,0x186c186e,0x1868186a,0x18e418e6,0x18e018e2,0x18641866,0x18601862
  .long 0x18dc18de,0x18d818da,0x185c185e,0x1858185a,0x18d418d6,0x18d018d2,0x18541856,0x18501852
  .long 0x18cc18ce,0x18c818ca,0x184c184e,0x1848184a,0x18c418c6,0x18c018c2,0x18441846,0x18401842
  .long 0x18bc18be,0x18b818ba,0x183c183e,0x1838183a,0x18b418b6,0x18b018b2,0x18341836,0x18301832
  .long 0x18ac18ae,0x18a818aa,0x182c182e,0x1828182a,0x18a418a6,0x18a018a2,0x18241826,0x18201822
  .long 0x189c189e,0x1898189a,0x181c181e,0x1818181a,0x18941896,0x18901892,0x18141816,0x18101812
  .long 0x188c188e,0x1888188a,0x180c180e,0x1808180a,0x18841886,0x18801882,0x18041806,0x18001802
  .long 0x1e001e00,0x1e001e00,0x1e001e00,0x1e001e00,0x1e001e00,0x1e001e00,0x1e001e00,0x1e001e00
.size L_tab_idx, .-L_tab_idx
L_tab_end:
.section .rodata,"a"
.p2align 6
.amdhsa_kernel parallel_sum__ssm_conv_s4d__moe_arch_mod__prompt_kernel
  .amdhsa_next_free_vgpr 216
  .amdhsa_next_free_sgpr 102
  .amdhsa_accum_offset 216
  .amdhsa_group_segment_fixed_size 0
  .amdhsa_kernarg_size 120
  .amdhsa_user_sgpr_count 2
  .amdhsa_user_sgpr_kernarg_segment_ptr 1
  .amdhsa_system_sgpr_workgroup_id_x 1
  .amdhsa_float_denorm_mode_32 3
.end_amdhsa_kernel
```
